```python
import torch

def _softmax(x, axis=-1):
    return torch.softmax(x, dim=axis)
def _gelu(x):
    return torch.nn.functional.gelu(x, approximate="tanh")
def _silu(x):
    return torch.nn.functional.silu(x)
def _sigmoid(x):
    return torch.sigmoid(x)
def _layernorm(x, axis=-1, eps=1e-5):
    m = x.mean(dim=axis, keepdim=True)
    v = x.var(dim=axis, keepdim=True, unbiased=False)
    return (x - m) / torch.sqrt(v + eps)
def _scatter_add(tgt, idx, src, axis=0):
    return tgt.clone().index_add_(axis, idx, src)
def _segment_sum(src, seg, n):
    out = torch.zeros((n,) + src.shape[1:], dtype=src.dtype)
    return out.index_add_(0, seg, src)
def _pad(x, pw):
    flat = tuple(v for pair in reversed(pw) for v in pair)
    return torch.nn.functional.pad(x, flat)

kernel_name = 'concat_heads__mha_block__softmax_full_mha__prompt'

def setup_inputs():

    _w = (lambda a: (lambda t: t.to(torch.bfloat16) if t.is_floating_point() else t)(torch.as_tensor(a)))
    def _A_setup():
        B, S, D, H = 1, 2048, 512, 32
        return {
            "x": _w((lambda *s: torch.randn(*s, dtype=torch.bfloat16) * 0.2)(B, S, D)),
            "wqkv": _w((lambda *s: torch.randn(*s, dtype=torch.bfloat16) * 0.2)(D, 3 * D)),
            "wo": _w((lambda *s: torch.randn(*s, dtype=torch.bfloat16) * 0.05)(D, D)),
        }
    _A_in = _A_setup()

    def _B_setup():
        B, S, D = 1, 2048, 512
        return {
            "x": _w((lambda *s: torch.randn(*s, dtype=torch.bfloat16) * 0.2)(B, S, D)),
            "wqkv": _w((lambda *s: torch.randn(*s, dtype=torch.bfloat16) * 0.2)(D, 3 * D)),
            "wo": _w((lambda *s: torch.randn(*s, dtype=torch.bfloat16) * 0.05)(D, D)),
        }
    _B_in = _B_setup()

    return {
        "A_x": _A_in["x"],
        "A_wqkv": _A_in["wqkv"],
        "A_wo": _A_in["wo"],
        "B_x": _B_in["x"],
        "B_wqkv": _B_in["wqkv"],
        "B_wo": _B_in["wo"],
    }

def reference(A_x, A_wqkv, A_wo, B_x, B_wqkv, B_wo):
    def _A_ref(x, wqkv, wo):
        B, S, D = x.shape
        H = 32
        Dh = D // H
        qkv = (lambda x, *d: x.permute(*d))((x @ wqkv).reshape(B, S, 3, H, Dh), 2, 0, 3, 1, 4)
        q, k, v = qkv[0], qkv[1], qkv[2]
        scores = torch.einsum("bhqd,bhkd->bhqk", q, k) * (Dh ** -0.5)
        p = _softmax(scores, axis=-1)
        o = torch.einsum("bhqk,bhkd->bhqd", p, v)
        return (lambda x, *d: x.permute(*d))(o, 0, 2, 1, 3).reshape(B, S, D) @ wo

    def _B_ref(x, wqkv, wo):
        B, S, D = x.shape
        H = 32; Dh = D // H
        qkv = (lambda x, *d: x.permute(*d))((x @ wqkv).reshape(B, S, 3, H, Dh), 2, 0, 3, 1, 4)
        q, k, v = qkv[0], qkv[1], qkv[2]
        scale = Dh ** -0.5
        scores = torch.einsum("bhqd,bhkd->bhqk", q, k) * scale
        p = _softmax(scores, axis=-1)
        o = torch.einsum("bhqk,bhkd->bhqd", p, v)
        return (lambda x, *d: x.permute(*d))(o, 0, 2, 1, 3).reshape(B, S, D) @ wo

    a = _A_ref(A_x, A_wqkv, A_wo)
    b = _B_ref(B_x, B_wqkv, B_wo)
    return torch.concatenate([a, b], axis=-1)
```

```asm
; @launch grid=(256,1,1) block=(512,1,1) lds=163840
.amdgcn_target "amdgcn-amd-amdhsa--gfx950"
.text
.globl concat_heads__mha_block__softmax_full_mha__prompt_kernel
.p2align 12
.type concat_heads__mha_block__softmax_full_mha__prompt_kernel,@function
concat_heads__mha_block__softmax_full_mha__prompt_kernel:
  s_cmp_ge_u32 s2, 256
  s_cbranch_scc1 L_done
  s_load_dwordx4 s[4:7], s[0:1], 0
  s_load_dwordx4 s[8:11], s[0:1], 24
  s_load_dwordx4 s[16:19], s[0:1], 56
  v_lshrrev_b32 v1, 6, v0
  v_and_b32 v0, 63, v0
  s_and_b32 s21, s2, 7
  v_readfirstlane_b32 s20, v1
  s_lshr_b32 s22, s2, 3
  s_lshr_b32 s23, s21, 2
  s_and_b32 s24, s21, 3
  s_lshl_b32 s25, s24, 1
  s_and_b32 s26, s22, 1
  s_add_u32 s25, s25, s26
  s_lshr_b32 s26, s22, 1
  s_mov_b32 s59, 0
  s_cmp_lt_u32 s20, 4
  s_cbranch_scc1 L_compute
L_loader:
  s_sub_u32 s34, s20, 4
  v_lshrrev_b32 v1, 3, v0
  v_lshlrev_b32 v1, 10, v1
  s_lshl_b32 s27, s34, 15
  v_add_u32 v1, s27, v1
  v_and_b32 v2, 7, v0
  v_lshrrev_b32 v3, 4, v0
  v_xor_b32 v4, v2, v3
  v_lshl_add_u32 v10, v4, 4, v1
  v_xor_b32 v4, 4, v4
  v_lshl_add_u32 v11, v4, 4, v1
  s_lshl_b32 s33, s34, 12
  s_and_b32 s29, s22, 1
  s_lshl_b32 s29, s29, 2
  s_mul_i32 s30, s26, 2
  s_add_u32 s29, s29, s30
  s_mul_i32 s30, s24, 0
  s_add_u32 s29, s29, s30
  s_lshl_b32 s27, s34, 4
  s_mul_i32 s36, s34, 6144
  s_add_u32 s36, s36, 16384
  v_add_u32 v1, 0, v0
  v_mul_u32_u24 v2, 2731, v1
  v_lshrrev_b32 v2, 16, v2
  v_mul_u32_u24 v3, 24, v2
  v_sub_u32 v3, v1, v3
  v_and_b32 v4, 2, v2
  v_lshlrev_b32 v4, 1, v4
  v_xor_b32 v3, v3, v4
  v_add_u32 v2, s27, v2
  v_mul_u32_u24 v2, 3072, v2
  v_lshrrev_b32 v5, 3, v3
  v_lshl_add_u32 v2, v5, 10, v2
  v_and_b32 v5, 7, v3
  v_lshl_add_u32 v12, v5, 4, v2
  v_xor_b32 v15, 32, v12
  v_add_u32 v1, 64, v0
  v_mul_u32_u24 v2, 2731, v1
  v_lshrrev_b32 v2, 16, v2
  v_mul_u32_u24 v3, 24, v2
  v_sub_u32 v3, v1, v3
  v_and_b32 v4, 2, v2
  v_lshlrev_b32 v4, 1, v4
  v_xor_b32 v3, v3, v4
  v_add_u32 v2, s27, v2
  v_mul_u32_u24 v2, 3072, v2
  v_lshrrev_b32 v5, 3, v3
  v_lshl_add_u32 v2, v5, 10, v2
  v_and_b32 v5, 7, v3
  v_lshl_add_u32 v13, v5, 4, v2
  v_xor_b32 v16, 32, v13
  v_add_u32 v1, 128, v0
  v_mul_u32_u24 v2, 2731, v1
  v_lshrrev_b32 v2, 16, v2
  v_mul_u32_u24 v3, 24, v2
  v_sub_u32 v3, v1, v3
  v_and_b32 v4, 2, v2
  v_lshlrev_b32 v4, 1, v4
  v_xor_b32 v3, v3, v4
  v_add_u32 v2, s27, v2
  v_mul_u32_u24 v2, 3072, v2
  v_lshrrev_b32 v5, 3, v3
  v_lshl_add_u32 v2, v5, 10, v2
  v_and_b32 v5, 7, v3
  v_lshl_add_u32 v14, v5, 4, v2
  v_xor_b32 v17, 32, v14
  s_cmp_eq_u32 s23, 0
  s_waitcnt lgkmcnt(0)
  s_cselect_b32 s4, s4, s8
  s_cselect_b32 s5, s5, s9
  s_cselect_b32 s6, s6, s10
  s_cselect_b32 s7, s7, s11
  s_lshl_b32 s27, s26, 17
  s_add_u32 s8, s4, s27
  s_addc_u32 s9, s5, 0
  s_mov_b32 s10, 131072
  s_mov_b32 s11, 0x20000
  s_add_u32 s31, s29, 0
  s_and_b32 s31, s31, 7
  s_lshl_b32 s31, s31, 7
  s_add_u32 m0, s33, 0
  s_add_u32 s35, s31, 0
  buffer_load_dwordx4 v10, s[8:11], s35 offen lds
  s_add_u32 m0, s33, 1024
  s_add_u32 s35, s31, 8192
  buffer_load_dwordx4 v11, s[8:11], s35 offen lds
  s_add_u32 m0, s33, 2048
  s_add_u32 s35, s31, 16384
  buffer_load_dwordx4 v10, s[8:11], s35 offen lds
  s_add_u32 m0, s33, 3072
  s_add_u32 s35, s31, 24576
  buffer_load_dwordx4 v11, s[8:11], s35 offen lds
  s_mov_b32 s12, s18
  s_mov_b32 s13, s19
  s_mov_b32 s14, 16797696
  s_mov_b32 s15, 0x20000
  s_mov_b32 s44, s16
  s_mov_b32 s45, s17
  s_mov_b32 s46, 256
  s_mov_b32 s47, 0x20000
  s_lshl_b32 s27, s25, 7
  s_add_u32 s16, s6, s27
  s_addc_u32 s17, s7, 0
  s_sub_u32 s18, 1572864, s27
  s_mov_b32 s19, 0x20000
  s_add_u32 s32, s29, 0
  s_and_b32 s32, s32, 7
  s_mul_i32 s32, s32, 196608
  s_add_u32 s30, s32, 24576
  s_add_u32 m0, s36, 0
  s_nop 0
  buffer_load_dwordx4 v12, s[16:19], s32 offen lds
  s_add_u32 m0, s36, 1024
  s_nop 0
  buffer_load_dwordx4 v13, s[16:19], s32 offen lds
  s_add_u32 m0, s36, 2048
  s_nop 0
  buffer_load_dwordx4 v14, s[16:19], s32 offen lds
  s_add_u32 m0, s36, 3072
  s_nop 0
  buffer_load_dwordx4 v15, s[16:19], s30 offen lds
  s_add_u32 m0, s36, 4096
  s_nop 0
  buffer_load_dwordx4 v16, s[16:19], s30 offen lds
  s_add_u32 m0, s36, 5120
  s_nop 0
  buffer_load_dwordx4 v17, s[16:19], s30 offen lds
  s_add_u32 s31, s29, 1
  s_and_b32 s31, s31, 7
  s_lshl_b32 s31, s31, 7
  s_add_u32 m0, s33, 40960
  s_add_u32 s35, s31, 0
  buffer_load_dwordx4 v10, s[8:11], s35 offen lds
  s_add_u32 m0, s33, 41984
  s_add_u32 s35, s31, 8192
  buffer_load_dwordx4 v11, s[8:11], s35 offen lds
  s_add_u32 m0, s33, 43008
  s_add_u32 s35, s31, 16384
  buffer_load_dwordx4 v10, s[8:11], s35 offen lds
  s_add_u32 m0, s33, 44032
  s_add_u32 s35, s31, 24576
  buffer_load_dwordx4 v11, s[8:11], s35 offen lds
  s_add_u32 s32, s29, 1
  s_and_b32 s32, s32, 7
  s_mul_i32 s32, s32, 196608
  s_add_u32 s30, s32, 24576
  s_add_u32 m0, s36, 40960
  s_nop 0
  buffer_load_dwordx4 v12, s[16:19], s32 offen lds
  s_add_u32 m0, s36, 41984
  s_nop 0
  buffer_load_dwordx4 v13, s[16:19], s32 offen lds
  s_add_u32 m0, s36, 43008
  s_nop 0
  buffer_load_dwordx4 v14, s[16:19], s32 offen lds
  s_add_u32 m0, s36, 44032
  s_nop 0
  buffer_load_dwordx4 v15, s[16:19], s30 offen lds
  s_add_u32 m0, s36, 45056
  s_nop 0
  buffer_load_dwordx4 v16, s[16:19], s30 offen lds
  s_add_u32 m0, s36, 46080
  s_nop 0
  buffer_load_dwordx4 v17, s[16:19], s30 offen lds
  s_waitcnt vmcnt(10)
  s_barrier
  s_add_u32 s31, s29, 2
  s_and_b32 s31, s31, 7
  s_lshl_b32 s31, s31, 7
  s_add_u32 m0, s33, 81920
  s_add_u32 s35, s31, 0
  buffer_load_dwordx4 v10, s[8:11], s35 offen lds
  s_add_u32 m0, s33, 82944
  s_add_u32 s35, s31, 8192
  buffer_load_dwordx4 v11, s[8:11], s35 offen lds
  s_add_u32 m0, s33, 83968
  s_add_u32 s35, s31, 16384
  buffer_load_dwordx4 v10, s[8:11], s35 offen lds
  s_add_u32 m0, s33, 84992
  s_add_u32 s35, s31, 24576
  buffer_load_dwordx4 v11, s[8:11], s35 offen lds
  s_add_u32 s32, s29, 2
  s_and_b32 s32, s32, 7
  s_mul_i32 s32, s32, 196608
  s_add_u32 s30, s32, 24576
  s_add_u32 m0, s36, 81920
  s_nop 0
  buffer_load_dwordx4 v12, s[16:19], s32 offen lds
  s_add_u32 m0, s36, 82944
  s_nop 0
  buffer_load_dwordx4 v13, s[16:19], s32 offen lds
  s_add_u32 m0, s36, 83968
  s_nop 0
  buffer_load_dwordx4 v14, s[16:19], s32 offen lds
  s_add_u32 m0, s36, 84992
  s_nop 0
  buffer_load_dwordx4 v15, s[16:19], s30 offen lds
  s_add_u32 m0, s36, 86016
  s_nop 0
  buffer_load_dwordx4 v16, s[16:19], s30 offen lds
  s_add_u32 m0, s36, 87040
  s_nop 0
  buffer_load_dwordx4 v17, s[16:19], s30 offen lds
  s_waitcnt vmcnt(10)
  s_barrier
  s_add_u32 s31, s29, 3
  s_and_b32 s31, s31, 7
  s_lshl_b32 s31, s31, 7
  s_add_u32 m0, s33, 122880
  s_add_u32 s35, s31, 0
  buffer_load_dwordx4 v10, s[8:11], s35 offen lds
  s_add_u32 m0, s33, 123904
  s_add_u32 s35, s31, 8192
  buffer_load_dwordx4 v11, s[8:11], s35 offen lds
  s_add_u32 m0, s33, 124928
  s_add_u32 s35, s31, 16384
  buffer_load_dwordx4 v10, s[8:11], s35 offen lds
  s_add_u32 m0, s33, 125952
  s_add_u32 s35, s31, 24576
  buffer_load_dwordx4 v11, s[8:11], s35 offen lds
  s_add_u32 s32, s29, 3
  s_and_b32 s32, s32, 7
  s_mul_i32 s32, s32, 196608
  s_add_u32 s30, s32, 24576
  s_add_u32 m0, s36, 122880
  s_nop 0
  buffer_load_dwordx4 v12, s[16:19], s32 offen lds
  s_add_u32 m0, s36, 123904
  s_nop 0
  buffer_load_dwordx4 v13, s[16:19], s32 offen lds
  s_add_u32 m0, s36, 124928
  s_nop 0
  buffer_load_dwordx4 v14, s[16:19], s32 offen lds
  s_add_u32 m0, s36, 125952
  s_nop 0
  buffer_load_dwordx4 v15, s[16:19], s30 offen lds
  s_add_u32 m0, s36, 126976
  s_nop 0
  buffer_load_dwordx4 v16, s[16:19], s30 offen lds
  s_add_u32 m0, s36, 128000
  s_nop 0
  buffer_load_dwordx4 v17, s[16:19], s30 offen lds
  s_waitcnt vmcnt(10)
  s_barrier
  s_add_u32 s31, s29, 4
  s_and_b32 s31, s31, 7
  s_lshl_b32 s31, s31, 7
  s_add_u32 m0, s33, 0
  s_add_u32 s35, s31, 0
  buffer_load_dwordx4 v10, s[8:11], s35 offen lds
  s_add_u32 m0, s33, 1024
  s_add_u32 s35, s31, 8192
  buffer_load_dwordx4 v11, s[8:11], s35 offen lds
  s_add_u32 m0, s33, 2048
  s_add_u32 s35, s31, 16384
  buffer_load_dwordx4 v10, s[8:11], s35 offen lds
  s_add_u32 m0, s33, 3072
  s_add_u32 s35, s31, 24576
  buffer_load_dwordx4 v11, s[8:11], s35 offen lds
  s_add_u32 s32, s29, 4
  s_and_b32 s32, s32, 7
  s_mul_i32 s32, s32, 196608
  s_add_u32 s30, s32, 24576
  s_add_u32 m0, s36, 0
  s_nop 0
  buffer_load_dwordx4 v12, s[16:19], s32 offen lds
  s_add_u32 m0, s36, 1024
  s_nop 0
  buffer_load_dwordx4 v13, s[16:19], s32 offen lds
  s_add_u32 m0, s36, 2048
  s_nop 0
  buffer_load_dwordx4 v14, s[16:19], s32 offen lds
  s_add_u32 m0, s36, 3072
  s_nop 0
  buffer_load_dwordx4 v15, s[16:19], s30 offen lds
  s_add_u32 m0, s36, 4096
  s_nop 0
  buffer_load_dwordx4 v16, s[16:19], s30 offen lds
  s_add_u32 m0, s36, 5120
  s_nop 0
  buffer_load_dwordx4 v17, s[16:19], s30 offen lds
  s_add_u32 s31, s29, 5
  s_and_b32 s31, s31, 7
  s_lshl_b32 s31, s31, 7
  s_add_u32 m0, s33, 40960
  s_add_u32 s35, s31, 0
  buffer_load_dwordx4 v10, s[8:11], s35 offen lds
  s_add_u32 m0, s33, 41984
  s_add_u32 s35, s31, 8192
  buffer_load_dwordx4 v11, s[8:11], s35 offen lds
  s_add_u32 m0, s33, 43008
  s_add_u32 s35, s31, 16384
  buffer_load_dwordx4 v10, s[8:11], s35 offen lds
  s_add_u32 m0, s33, 44032
  s_add_u32 s35, s31, 24576
  buffer_load_dwordx4 v11, s[8:11], s35 offen lds
  s_waitcnt vmcnt(14)
  s_barrier
  s_add_u32 s32, s29, 5
  s_and_b32 s32, s32, 7
  s_mul_i32 s32, s32, 196608
  s_add_u32 s30, s32, 24576
  s_add_u32 m0, s36, 40960
  s_nop 0
  buffer_load_dwordx4 v12, s[16:19], s32 offen lds
  s_add_u32 m0, s36, 41984
  s_nop 0
  buffer_load_dwordx4 v13, s[16:19], s32 offen lds
  s_add_u32 m0, s36, 43008
  s_nop 0
  buffer_load_dwordx4 v14, s[16:19], s32 offen lds
  s_add_u32 m0, s36, 44032
  s_nop 0
  buffer_load_dwordx4 v15, s[16:19], s30 offen lds
  s_add_u32 m0, s36, 45056
  s_nop 0
  buffer_load_dwordx4 v16, s[16:19], s30 offen lds
  s_add_u32 m0, s36, 46080
  s_nop 0
  buffer_load_dwordx4 v17, s[16:19], s30 offen lds
  s_add_u32 s31, s29, 6
  s_and_b32 s31, s31, 7
  s_lshl_b32 s31, s31, 7
  s_add_u32 m0, s33, 81920
  s_add_u32 s35, s31, 0
  buffer_load_dwordx4 v10, s[8:11], s35 offen lds
  s_add_u32 m0, s33, 82944
  s_add_u32 s35, s31, 8192
  buffer_load_dwordx4 v11, s[8:11], s35 offen lds
  s_add_u32 m0, s33, 83968
  s_add_u32 s35, s31, 16384
  buffer_load_dwordx4 v10, s[8:11], s35 offen lds
  s_add_u32 m0, s33, 84992
  s_add_u32 s35, s31, 24576
  buffer_load_dwordx4 v11, s[8:11], s35 offen lds
  s_add_u32 s32, s29, 6
  s_and_b32 s32, s32, 7
  s_mul_i32 s32, s32, 196608
  s_add_u32 s30, s32, 24576
  s_add_u32 m0, s36, 81920
  s_nop 0
  buffer_load_dwordx4 v12, s[16:19], s32 offen lds
  s_add_u32 m0, s36, 82944
  s_nop 0
  buffer_load_dwordx4 v13, s[16:19], s32 offen lds
  s_add_u32 m0, s36, 83968
  s_nop 0
  buffer_load_dwordx4 v14, s[16:19], s32 offen lds
  s_add_u32 m0, s36, 84992
  s_nop 0
  buffer_load_dwordx4 v15, s[16:19], s30 offen lds
  s_add_u32 m0, s36, 86016
  s_nop 0
  buffer_load_dwordx4 v16, s[16:19], s30 offen lds
  s_add_u32 m0, s36, 87040
  s_nop 0
  buffer_load_dwordx4 v17, s[16:19], s30 offen lds
  s_waitcnt vmcnt(20)
  s_barrier
  s_add_u32 s31, s29, 7
  s_and_b32 s31, s31, 7
  s_lshl_b32 s31, s31, 7
  s_add_u32 m0, s33, 122880
  s_add_u32 s35, s31, 0
  buffer_load_dwordx4 v10, s[8:11], s35 offen lds
  s_add_u32 m0, s33, 123904
  s_add_u32 s35, s31, 8192
  buffer_load_dwordx4 v11, s[8:11], s35 offen lds
  s_add_u32 m0, s33, 124928
  s_add_u32 s35, s31, 16384
  buffer_load_dwordx4 v10, s[8:11], s35 offen lds
  s_add_u32 m0, s33, 125952
  s_add_u32 s35, s31, 24576
  buffer_load_dwordx4 v11, s[8:11], s35 offen lds
  s_add_u32 s32, s29, 7
  s_and_b32 s32, s32, 7
  s_mul_i32 s32, s32, 196608
  s_add_u32 s30, s32, 24576
  s_add_u32 m0, s36, 122880
  s_nop 0
  buffer_load_dwordx4 v12, s[16:19], s32 offen lds
  s_add_u32 m0, s36, 123904
  s_nop 0
  buffer_load_dwordx4 v13, s[16:19], s32 offen lds
  s_add_u32 m0, s36, 124928
  s_nop 0
  buffer_load_dwordx4 v14, s[16:19], s32 offen lds
  s_add_u32 m0, s36, 125952
  s_nop 0
  buffer_load_dwordx4 v15, s[16:19], s30 offen lds
  s_add_u32 m0, s36, 126976
  s_nop 0
  buffer_load_dwordx4 v16, s[16:19], s30 offen lds
  s_add_u32 m0, s36, 128000
  s_nop 0
  buffer_load_dwordx4 v17, s[16:19], s30 offen lds
  s_waitcnt vmcnt(20)
  s_barrier
  s_lshl_b32 s27, s23, 5
  s_lshl_b32 s28, s25, 2
  s_add_u32 s27, s27, s28
  s_add_u32 s27, s27, s34
  s_lshl_b32 s27, s27, 16
  s_lshl_b32 s28, s26, 12
  s_add_u32 s27, s27, s28
  s_add_u32 s28, s27, 8388608
  v_and_b32 v1, 31, v0
  v_lshlrev_b32 v1, 7, v1
  v_lshrrev_b32 v2, 5, v0
  v_lshl_or_b32 v2, v2, 22, v1
  buffer_load_dword v255, v2, s[12:15], s27 offen
  buffer_load_dword v255, v1, s[12:15], s28 offen
  s_waitcnt vmcnt(12)
  s_barrier
  s_waitcnt vmcnt(2)
  s_barrier
  s_load_dwordx2 s[4:5], s[0:1], 16
  s_load_dwordx2 s[6:7], s[0:1], 40
  s_lshl_b32 s27, s23, 5
  s_lshl_b32 s28, s24, 3
  s_add_u32 s27, s27, s28
  s_and_b32 s28, s22, 7
  s_add_u32 s27, s27, s28
  s_lshl_b32 s27, s27, 16
  s_and_b32 s28, s34, 1
  s_lshr_b32 s29, s34, 1
  s_lshl_b32 s30, s28, 22
  s_add_u32 s30, s30, s27
  s_add_u32 s30, s30, 4194304
  s_add_u32 s8, s12, s30
  s_addc_u32 s9, s13, 0
  s_mov_b32 s10, 65536
  s_mov_b32 s11, 0x20000
  s_lshr_b32 s30, s22, 3
  s_lshl_b32 s30, s30, 4
  s_lshl_b32 s31, s34, 2
  s_add_u32 s30, s30, s31
  s_lshl_b32 s30, s30, 10
  s_add_u32 s37, s30, s27
  s_lshl_b32 s38, s34, 12
  s_add_u32 s38, s38, 135168
  s_lshr_b32 s30, s22, 3
  s_lshl_b32 s41, s30, 4
  s_lshl_b64 s[42:43], 0xffff, s41
  s_mul_i32 s41, s41, 1
  s_add_u32 s39, s29, s41
  s_lshl_b32 s39, s39, 10
  s_movk_i32 s30, 1024
  s_cmp_eq_u32 s28, 0
  s_cselect_b32 s30, s30, 1056
  s_cselect_b32 s31, 0, 65536
  s_mul_i32 s32, s29, s30
  s_add_u32 s31, s31, s32
  s_lshl_b32 s30, s30, 1
  s_lshl_b32 s40, s21, 1
  s_bfe_u32 s41, s22, 0x10002
  s_add_u32 s40, s40, s41
  s_lshl_b32 s40, s40, 9
  s_add_u32 s40, s40, 16777216
  v_lshlrev_b32 v5, 4, v0
  v_lshlrev_b32 v3, 3, v0
  v_mov_b32 v4, 0
  v_mov_b32 v8, 0x3f803f80
  v_mov_b32 v9, 0x3f803f80
  v_mov_b32 v10, 0x3f803f80
  v_mov_b32 v11, 0x3f803f80
  v_mov_b32 v12, 0
  v_mov_b32 v13, 0
  v_mov_b32 v14, 0
  v_mov_b32 v15, 0
  v_mul_u32_u24 v1, 1056, v0
  v_add_u32 v1, 66560, v1
  s_mov_b32 s58, 0
  s_barrier
  ds_write_b128 v1, v[8:11]
  ds_write_b128 v1, v[12:15] offset:16
Ll_poll:
  buffer_load_dwordx2 v[16:17], v4, s[44:47], 0 offen sc1
  buffer_load_dwordx2 v[18:19], v3, s[12:15], s40 offen sc1
  s_waitcnt vmcnt(0)
  v_cmp_ne_u64 vcc, v[16:17], v[18:19]
  v_cmp_eq_u32 s[48:49], 0, v16
  s_nop 1
  s_and_b64 vcc, vcc, s[42:43]
  s_or_b64 vcc, vcc, s[48:49]
  s_cbranch_vccz Ll_go
  s_sleep 1
  s_add_u32 s58, s58, 1
  s_cmp_lt_u32 s58, 131072
  s_cbranch_scc1 Ll_poll
Ll_go:
  s_mov_b32 m0, s38
  s_nop 0
  buffer_load_dwordx4 v5, s[12:15], s37 offen sc1 lds
  buffer_load_dwordx4 v5, s[12:15], s37 offen offset:1024 sc1 lds
  buffer_load_dwordx4 v5, s[12:15], s37 offen offset:2048 sc1 lds
  buffer_load_dwordx4 v5, s[12:15], s37 offen offset:3072 sc1 lds
  s_movk_i32 s35, 4
Ll_kv1:
  s_mov_b32 m0, s31
  s_add_u32 s31, s31, s30
  buffer_load_dwordx4 v5, s[8:11], s39 offen sc1 lds
  s_add_u32 s39, s39, 2048
  s_and_b32 s39, s39, 0xffff
  s_sub_u32 s35, s35, 1
  s_cmp_lg_u32 s35, 0
  s_cbranch_scc1 Ll_kv1
  s_waitcnt vmcnt(0) lgkmcnt(0)
  s_barrier
Ll_poll2:
  buffer_load_dwordx2 v[18:19], v3, s[12:15], s40 offen sc1
  s_waitcnt vmcnt(0)
  v_cmp_ne_u64 vcc, v[16:17], v[18:19]
  s_cbranch_vccz Ll_go2
  s_sleep 1
  s_add_u32 s58, s58, 1
  s_cmp_lt_u32 s58, 131072
  s_cbranch_scc1 Ll_poll2
Ll_go2:
  s_movk_i32 s35, 28
Ll_kv2:
  s_mov_b32 m0, s31
  s_add_u32 s31, s31, s30
  buffer_load_dwordx4 v5, s[8:11], s39 offen sc1 lds
  s_add_u32 s39, s39, 2048
  s_and_b32 s39, s39, 0xffff
  s_sub_u32 s35, s35, 1
  s_cmp_lg_u32 s35, 0
  s_cbranch_scc1 Ll_kv2
  v_lshrrev_b32 v3, 3, v0
  v_lshlrev_b32 v3, 10, v3
  v_bfe_u32 v4, v0, 4, 1
  v_lshlrev_b32 v4, 2, v4
  v_and_b32 v2, 7, v0
  v_xor_b32 v4, v4, v2
  v_lshl_add_u32 v3, v4, 4, v3
  s_and_b32 s28, s22, 7
  s_lshl_b32 s28, s28, 7
  s_cmp_eq_u32 s23, 0
  s_waitcnt vmcnt(0) lgkmcnt(0)
  s_cselect_b32 s4, s4, s6
  s_cselect_b32 s5, s5, s7
  s_barrier
  s_add_u32 s16, s4, s28
  s_addc_u32 s17, s5, 0
  s_sub_u32 s18, 524288, s28
  s_mov_b32 s19, 0x20000
  s_lshl_b32 s27, s34, 13
  buffer_load_dwordx4 v[64:67], v3, s[16:19], s27 offen
  s_add_u32 s27, s27, 32768
  buffer_load_dwordx4 v[68:71], v3, s[16:19], s27 offen
  s_add_u32 s27, s27, 32768
  buffer_load_dwordx4 v[72:75], v3, s[16:19], s27 offen
  s_add_u32 s27, s27, 32768
  buffer_load_dwordx4 v[76:79], v3, s[16:19], s27 offen
  s_add_u32 s27, s27, 32768
  buffer_load_dwordx4 v[80:83], v3, s[16:19], s27 offen
  s_add_u32 s27, s27, 32768
  buffer_load_dwordx4 v[84:87], v3, s[16:19], s27 offen
  s_add_u32 s27, s27, 32768
  buffer_load_dwordx4 v[88:91], v3, s[16:19], s27 offen
  s_add_u32 s27, s27, 32768
  buffer_load_dwordx4 v[92:95], v3, s[16:19], s27 offen
  s_add_u32 s27, s27, 32768
  buffer_load_dwordx4 v[96:99], v3, s[16:19], s27 offen
  s_add_u32 s27, s27, 32768
  buffer_load_dwordx4 v[100:103], v3, s[16:19], s27 offen
  s_add_u32 s27, s27, 32768
  buffer_load_dwordx4 v[104:107], v3, s[16:19], s27 offen
  s_add_u32 s27, s27, 32768
  buffer_load_dwordx4 v[108:111], v3, s[16:19], s27 offen
  s_add_u32 s27, s27, 32768
  buffer_load_dwordx4 v[112:115], v3, s[16:19], s27 offen
  s_add_u32 s27, s27, 32768
  buffer_load_dwordx4 v[116:119], v3, s[16:19], s27 offen
  s_add_u32 s27, s27, 32768
  buffer_load_dwordx4 v[120:123], v3, s[16:19], s27 offen
  s_add_u32 s27, s27, 32768
  buffer_load_dwordx4 v[124:127], v3, s[16:19], s27 offen
  s_add_u32 s27, s27, 32768
  s_and_b32 s27, s22, 27
  s_or_b32 s27, s27, s34
  s_cmp_lg_u32 s27, 0
  s_cbranch_scc1 Ll_nowb
  buffer_wbl2 sc1
Ll_nowb:
  s_lshl_b32 s27, s34, 10
  v_add_u32 v5, s27, v5
  s_waitcnt vmcnt(0)
  s_barrier
  ds_write_b128 v5, v[64:67] offset:0
  ds_write_b128 v5, v[68:71] offset:4096
  ds_write_b128 v5, v[72:75] offset:8192
  ds_write_b128 v5, v[76:79] offset:12288
  ds_write_b128 v5, v[80:83] offset:16384
  ds_write_b128 v5, v[84:87] offset:20480
  ds_write_b128 v5, v[88:91] offset:24576
  ds_write_b128 v5, v[92:95] offset:28672
  ds_write_b128 v5, v[96:99] offset:32768
  ds_write_b128 v5, v[100:103] offset:36864
  ds_write_b128 v5, v[104:107] offset:40960
  ds_write_b128 v5, v[108:111] offset:45056
  ds_write_b128 v5, v[112:115] offset:49152
  ds_write_b128 v5, v[116:119] offset:53248
  ds_write_b128 v5, v[120:123] offset:57344
  ds_write_b128 v5, v[124:127] offset:61440
  s_cmp_lg_u32 s34, 0
  s_cbranch_scc1 Ll_p3done
  s_lshl_b32 s27, s21, 2
  s_lshr_b32 s28, s22, 3
  s_add_u32 s27, s27, s28
  s_lshl_b32 s27, s27, 8
  s_add_u32 s27, s27, 16785408
  v_and_b32 v3, 31, v0
  v_lshlrev_b32 v3, 3, v3
  s_mov_b32 s58, 0
Ll_p3:
  buffer_load_dwordx2 v[18:19], v3, s[12:15], s27 offen sc1
  s_waitcnt vmcnt(0)
  v_cmp_ne_u64 vcc, v[16:17], v[18:19]
  s_cbranch_vccz Ll_p3done
  s_sleep 1
  s_add_u32 s58, s58, 1
  s_cmp_lt_u32 s58, 131072
  s_cbranch_scc1 Ll_p3
Ll_p3done:
  s_waitcnt lgkmcnt(0)
  s_barrier
L_done:
  s_endpgm
.p2align 12
L1_jobs:
  s_cmp_lg_u32 s44, 0
  s_cbranch_scc1 L1_late
  s_cmp_lt_u32 s31, 2
  s_cbranch_scc1 L1_reqtag
  s_waitcnt vmcnt(0)
  v_readfirstlane_b32 s29, v216
  s_cmp_eq_u32 s29, 0
  s_cbranch_scc1 L1_reqtag
  s_mov_b32 s44, 1
  s_movk_i32 s47, 32
  s_mov_b64 exec, 1
  buffer_store_dwordx4 v[216:219], v220, s[12:15], s45 offen sc1
  s_mov_b64 exec, -1
  s_branch L1_late
L1_reqtag:
  buffer_load_dwordx2 v[216:217], v220, s[8:11], 0 offen sc1
L1_late:
  s_cmp_lg_u32 s31, 5
  s_cbranch_scc1 L1_back
  buffer_load_dwordx2 v[224:225], v220, s[8:11], 0 offen sc1
  buffer_load_dwordx4 v[228:231], v221, s[12:15], s41 offen sc1
  s_branch L1_back
L_compute:
  s_cmp_eq_u32 s23, 0
  s_waitcnt lgkmcnt(0)
  s_cselect_b32 s4, s4, s8
  s_cselect_b32 s5, s5, s9
  s_cselect_b32 s6, s6, s10
  s_cselect_b32 s7, s7, s11
  s_mov_b32 s12, s18
  s_mov_b32 s13, s19
  s_mov_b32 s14, 16797696
  s_mov_b32 s15, 0x20000
  s_mov_b32 s8, s16
  s_mov_b32 s9, s17
  s_mov_b32 s10, 256
  s_mov_b32 s11, 0x20000
  s_or_b32 s27, s2, s20
  s_cmp_lg_u32 s27, 0
  s_cbranch_scc1 L_tagdone
  s_memrealtime s[28:29]
  v_mov_b32 v4, 0
  s_waitcnt lgkmcnt(0)
  s_or_b32 s28, s28, 1
  v_mov_b32 v2, s28
  v_mov_b32 v3, s29
  s_mov_b64 exec, 1
  buffer_store_dwordx2 v[2:3], v4, s[8:11], 0 offen sc1
  s_mov_b64 exec, -1
L_tagdone:
  s_lshr_b32 s34, s20, 1
  s_and_b32 s35, s20, 1
  v_and_b32 v13, 15, v0
  v_lshrrev_b32 v14, 4, v0
  v_bfe_u32 v15, v0, 1, 3
  s_lshl_b32 s36, s34, 13
  v_xor_b32 v7, v14, v15
  v_lshlrev_b32 v7, 4, v7
  v_lshl_add_u32 v7, v13, 7, v7
  v_add_u32 v2, s36, v7
  v_xor_b32 v3, 64, v2
  v_bfe_u32 v7, v0, 2, 2
  v_lshl_add_u32 v7, v14, 3, v7
  v_mul_u32_u24 v7, 384, v7
  v_bfe_u32 v13, v0, 3, 1
  v_bfe_u32 v15, v0, 4, 1
  v_lshl_or_b32 v13, v13, 1, v15
  s_lshl_b32 s36, s35, 1
  v_xor_b32 v13, s36, v13
  v_lshl_add_u32 v7, v13, 5, v7
  v_and_b32 v13, 3, v0
  v_lshl_add_u32 v7, v13, 3, v7
  v_add_u32 v4, 16384, v7
  v_xor_b32 v5, 32, v4
  v_mov_b64 v[16:17], 0
  v_mov_b64 v[18:19], 0
  v_mov_b64 v[20:21], 0
  v_mov_b64 v[22:23], 0
  v_mov_b64 v[24:25], 0
  v_mov_b64 v[26:27], 0
  v_mov_b64 v[28:29], 0
  v_mov_b64 v[30:31], 0
  v_mov_b64 v[32:33], 0
  v_mov_b64 v[34:35], 0
  v_mov_b64 v[36:37], 0
  v_mov_b64 v[38:39], 0
  v_mov_b64 v[40:41], 0
  v_mov_b64 v[42:43], 0
  v_mov_b64 v[44:45], 0
  v_mov_b64 v[46:47], 0
  v_mov_b64 v[48:49], 0
  v_mov_b64 v[50:51], 0
  v_mov_b64 v[52:53], 0
  v_mov_b64 v[54:55], 0
  v_mov_b64 v[56:57], 0
  v_mov_b64 v[58:59], 0
  v_mov_b64 v[60:61], 0
  v_mov_b64 v[62:63], 0
  v_mov_b64 v[64:65], 0
  v_mov_b64 v[66:67], 0
  v_mov_b64 v[68:69], 0
  v_mov_b64 v[70:71], 0
  v_mov_b64 v[72:73], 0
  v_mov_b64 v[74:75], 0
  v_mov_b64 v[76:77], 0
  v_mov_b64 v[78:79], 0
  v_mov_b64 v[80:81], 0
  v_mov_b64 v[82:83], 0
  v_mov_b64 v[84:85], 0
  v_mov_b64 v[86:87], 0
  v_mov_b64 v[88:89], 0
  v_mov_b64 v[90:91], 0
  v_mov_b64 v[92:93], 0
  v_mov_b64 v[94:95], 0
  v_mov_b64 v[96:97], 0
  v_mov_b64 v[98:99], 0
  v_mov_b64 v[100:101], 0
  v_mov_b64 v[102:103], 0
  v_mov_b64 v[104:105], 0
  v_mov_b64 v[106:107], 0
  v_mov_b64 v[108:109], 0
  v_mov_b64 v[110:111], 0
  v_mov_b32 v8, v2
  v_mov_b32 v9, v3
  v_mov_b32 v10, v4
  v_mov_b32 v11, v5
  s_lshl_b32 s37, s23, 5
  s_lshl_b32 s38, s25, 2
  s_add_u32 s37, s37, s38
  s_lshl_b32 s38, s35, 1
  s_add_u32 s37, s37, s38
  s_lshl_b32 s37, s37, 16
  s_lshl_b32 s38, s26, 2
  s_lshl_b32 s39, s34, 1
  s_add_u32 s38, s38, s39
  s_lshl_b32 s38, s38, 10
  s_add_u32 s38, s37, s38
  s_add_u32 s39, s38, 4194304
  s_add_u32 s40, s38, 8388608
  v_lshlrev_b32 v212, 4, v0
  v_add_u32 v213, 0x10000, v212
  v_and_b32 v7, 15, v0
  v_lshrrev_b32 v14, 5, v0
  v_lshl_or_b32 v13, v14, 4, v7
  v_lshlrev_b32 v13, 4, v13
  v_bfe_u32 v15, v0, 4, 1
  v_lshl_or_b32 v214, v15, 16, v13
  v_and_b32 v221, 31, v0
  v_lshlrev_b32 v221, 4, v221
  s_getreg_b32 s46, hwreg(HW_REG_XCC_ID)
  s_and_b32 s46, s46, 15
  v_mov_b32 v218, s46
  v_mov_b32 v219, 0
  v_mov_b32 v220, 0
  s_lshl_b32 s41, s21, 9
  s_add_u32 s41, s41, 16793600
  s_lshl_b32 s45, s22, 4
  s_add_u32 s45, s45, s41
  s_min_u32 s44, s20, 1
  s_cmp_eq_u32 s20, 0
  s_movk_i32 s47, 32
  s_cselect_b32 s47, 0x7f, s47
  s_lshl_b32 s42, s21, 1
  s_and_b32 s43, s22, 1
  s_add_u32 s42, s42, s43
  s_lshl_b32 s42, s42, 9
  s_lshl_b32 s43, s26, 5
  s_add_u32 s42, s42, s43
  s_lshl_b32 s43, s20, 3
  s_add_u32 s42, s42, s43
  s_add_u32 s42, s42, 16777216
  s_mov_b32 s36, 0x3eb8aa3b
  s_mov_b32 s37, 0x3eb8aa3b
  s_mov_b32 s31, 0
  s_mov_b32 s32, 0
  s_mov_b32 s53, 1
  s_cmp_eq_u32 s20, 1
  s_cbranch_scc1 L2_page
  s_cmp_eq_u32 s20, 2
  s_cbranch_scc1 L3_page
L1_touched:
  s_mov_b32 s53, 0
  s_barrier
  ds_read_b128 v[112:115], v8 offset:0
  ds_read_b128 v[116:119], v8 offset:2048
  ds_read_b128 v[120:123], v8 offset:4096
  ds_read_b128 v[124:127], v8 offset:6144
  ds_read_b64_tr_b16 v[136:137], v10 offset:128
  ds_read_b64_tr_b16 v[138:139], v10 offset:1664
  ds_read_b64_tr_b16 v[140:141], v11 offset:128
  ds_read_b64_tr_b16 v[142:143], v11 offset:1664
  ds_read_b64_tr_b16 v[144:145], v10 offset:256
  ds_read_b64_tr_b16 v[146:147], v10 offset:1792
  ds_read_b64_tr_b16 v[148:149], v11 offset:256
  ds_read_b64_tr_b16 v[150:151], v11 offset:1792
  ds_read_b64_tr_b16 v[128:129], v10 offset:0
  ds_read_b64_tr_b16 v[130:131], v10 offset:1536
  ds_read_b64_tr_b16 v[132:133], v11 offset:0
  ds_read_b64_tr_b16 v[134:135], v11 offset:1536
.p2align 3
L1_loop:
  s_waitcnt lgkmcnt(0)
  v_mfma_f32_16x16x32_bf16 v[48:51], v[136:139], v[112:115], v[48:51]
  ds_read_b128 v[152:155], v9 offset:0
  ds_read_b128 v[156:159], v9 offset:2048
  v_mfma_f32_16x16x32_bf16 v[52:55], v[136:139], v[116:119], v[52:55]
  ds_read_b128 v[160:163], v9 offset:4096
  ds_read_b128 v[164:167], v9 offset:6144
  v_mfma_f32_16x16x32_bf16 v[56:59], v[136:139], v[120:123], v[56:59]
  ds_read_b64_tr_b16 v[176:177], v10 offset:12416
  ds_read_b64_tr_b16 v[178:179], v10 offset:13952
  v_mfma_f32_16x16x32_bf16 v[60:63], v[136:139], v[124:127], v[60:63]
  ds_read_b64_tr_b16 v[180:181], v11 offset:12416
  ds_read_b64_tr_b16 v[182:183], v11 offset:13952
  v_mfma_f32_16x16x32_bf16 v[64:67], v[140:143], v[112:115], v[64:67]
  ds_read_b64_tr_b16 v[184:185], v10 offset:12544
  v_mfma_f32_16x16x32_bf16 v[68:71], v[140:143], v[116:119], v[68:71]
  ds_read_b64_tr_b16 v[186:187], v10 offset:14080
  v_mfma_f32_16x16x32_bf16 v[72:75], v[140:143], v[120:123], v[72:75]
  ds_read_b64_tr_b16 v[188:189], v11 offset:12544
  v_mfma_f32_16x16x32_bf16 v[76:79], v[140:143], v[124:127], v[76:79]
  ds_read_b64_tr_b16 v[190:191], v11 offset:14080
  v_mfma_f32_16x16x32_bf16 v[80:83], v[112:115], v[144:147], v[80:83]
  ds_read_b64_tr_b16 v[168:169], v10 offset:12288
  v_mfma_f32_16x16x32_bf16 v[84:87], v[112:115], v[148:151], v[84:87]
  ds_read_b64_tr_b16 v[170:171], v10 offset:13824
  v_mfma_f32_16x16x32_bf16 v[88:91], v[116:119], v[144:147], v[88:91]
  ds_read_b64_tr_b16 v[172:173], v11 offset:12288
  v_mfma_f32_16x16x32_bf16 v[92:95], v[116:119], v[148:151], v[92:95]
  ds_read_b64_tr_b16 v[174:175], v11 offset:13824
  v_mfma_f32_16x16x32_bf16 v[96:99], v[120:123], v[144:147], v[96:99]
  v_mfma_f32_16x16x32_bf16 v[100:103], v[120:123], v[148:151], v[100:103]
  s_add_u32 s32, s32, 40960
  s_cmp_eq_u32 s32, 163840
  v_mfma_f32_16x16x32_bf16 v[104:107], v[124:127], v[144:147], v[104:107]
  s_cselect_b32 s32, 0, s32
  s_bitcmp1_b32 s47, s31
  s_cbranch_scc1 L1_jobs
L1_back:
  v_mfma_f32_16x16x32_bf16 v[108:111], v[124:127], v[148:151], v[108:111]
  v_mfma_f32_16x16x32_bf16 v[16:19], v[128:131], v[112:115], v[16:19]
  v_add_u32 v8, s32, v2
  v_add_u32 v9, s32, v3
  v_mfma_f32_16x16x32_bf16 v[20:23], v[128:131], v[116:119], v[20:23]
  v_add_u32 v10, s32, v4
  v_add_u32 v11, s32, v5
  v_mfma_f32_16x16x32_bf16 v[24:27], v[128:131], v[120:123], v[24:27]
  v_mfma_f32_16x16x32_bf16 v[28:31], v[128:131], v[124:127], v[28:31]
  v_mfma_f32_16x16x32_bf16 v[32:35], v[132:135], v[112:115], v[32:35]
  v_mfma_f32_16x16x32_bf16 v[36:39], v[132:135], v[116:119], v[36:39]
  s_add_u32 s31, s31, 1
  v_mfma_f32_16x16x32_bf16 v[40:43], v[132:135], v[120:123], v[40:43]
  v_mfma_f32_16x16x32_bf16 v[44:47], v[132:135], v[124:127], v[44:47]
  s_waitcnt lgkmcnt(0)
  v_mfma_f32_16x16x32_bf16 v[48:51], v[176:179], v[152:155], v[48:51]
  s_barrier
  v_mfma_f32_16x16x32_bf16 v[52:55], v[176:179], v[156:159], v[52:55]
  ds_read_b128 v[112:115], v8 offset:0
  ds_read_b128 v[116:119], v8 offset:2048
  v_mfma_f32_16x16x32_bf16 v[56:59], v[176:179], v[160:163], v[56:59]
  ds_read_b128 v[120:123], v8 offset:4096
  ds_read_b128 v[124:127], v8 offset:6144
  v_mfma_f32_16x16x32_bf16 v[60:63], v[176:179], v[164:167], v[60:63]
  ds_read_b64_tr_b16 v[136:137], v10 offset:128
  ds_read_b64_tr_b16 v[138:139], v10 offset:1664
  v_mfma_f32_16x16x32_bf16 v[64:67], v[180:183], v[152:155], v[64:67]
  ds_read_b64_tr_b16 v[140:141], v11 offset:128
  ds_read_b64_tr_b16 v[142:143], v11 offset:1664
  v_mfma_f32_16x16x32_bf16 v[68:71], v[180:183], v[156:159], v[68:71]
  ds_read_b64_tr_b16 v[144:145], v10 offset:256
  v_mfma_f32_16x16x32_bf16 v[72:75], v[180:183], v[160:163], v[72:75]
  ds_read_b64_tr_b16 v[146:147], v10 offset:1792
  v_mfma_f32_16x16x32_bf16 v[76:79], v[180:183], v[164:167], v[76:79]
  ds_read_b64_tr_b16 v[148:149], v11 offset:256
  v_mfma_f32_16x16x32_bf16 v[80:83], v[152:155], v[184:187], v[80:83]
  ds_read_b64_tr_b16 v[150:151], v11 offset:1792
  v_mfma_f32_16x16x32_bf16 v[84:87], v[152:155], v[188:191], v[84:87]
  ds_read_b64_tr_b16 v[128:129], v10 offset:0
  v_mfma_f32_16x16x32_bf16 v[88:91], v[156:159], v[184:187], v[88:91]
  ds_read_b64_tr_b16 v[130:131], v10 offset:1536
  v_mfma_f32_16x16x32_bf16 v[92:95], v[156:159], v[188:191], v[92:95]
  ds_read_b64_tr_b16 v[132:133], v11 offset:0
  v_mfma_f32_16x16x32_bf16 v[96:99], v[160:163], v[184:187], v[96:99]
  ds_read_b64_tr_b16 v[134:135], v11 offset:1536
  v_mfma_f32_16x16x32_bf16 v[100:103], v[160:163], v[188:191], v[100:103]
  v_mfma_f32_16x16x32_bf16 v[104:107], v[164:167], v[184:187], v[104:107]
  v_mfma_f32_16x16x32_bf16 v[108:111], v[164:167], v[188:191], v[108:111]
  v_mfma_f32_16x16x32_bf16 v[16:19], v[168:171], v[152:155], v[16:19]
  v_mfma_f32_16x16x32_bf16 v[20:23], v[168:171], v[156:159], v[20:23]
  v_mfma_f32_16x16x32_bf16 v[24:27], v[168:171], v[160:163], v[24:27]
  v_mfma_f32_16x16x32_bf16 v[28:31], v[168:171], v[164:167], v[28:31]
  v_mfma_f32_16x16x32_bf16 v[32:35], v[172:175], v[152:155], v[32:35]
  v_mfma_f32_16x16x32_bf16 v[36:39], v[172:175], v[156:159], v[36:39]
  s_cmp_lg_u32 s31, 6
  v_mfma_f32_16x16x32_bf16 v[40:43], v[172:175], v[160:163], v[40:43]
  v_mfma_f32_16x16x32_bf16 v[44:47], v[172:175], v[164:167], v[44:47]
  s_cbranch_scc1 L1_loop
  s_waitcnt lgkmcnt(0)
  v_mfma_f32_16x16x32_bf16 v[48:51], v[136:139], v[112:115], v[48:51]
  ds_read_b128 v[152:155], v9 offset:0
  v_mfma_f32_16x16x32_bf16 v[52:55], v[136:139], v[116:119], v[52:55]
  ds_read_b128 v[156:159], v9 offset:2048
  v_mfma_f32_16x16x32_bf16 v[56:59], v[136:139], v[120:123], v[56:59]
  ds_read_b128 v[160:163], v9 offset:4096
  v_mfma_f32_16x16x32_bf16 v[60:63], v[136:139], v[124:127], v[60:63]
  ds_read_b128 v[164:167], v9 offset:6144
  v_mfma_f32_16x16x32_bf16 v[64:67], v[140:143], v[112:115], v[64:67]
  ds_read_b64_tr_b16 v[200:201], v10 offset:12416
  v_mfma_f32_16x16x32_bf16 v[68:71], v[140:143], v[116:119], v[68:71]
  ds_read_b64_tr_b16 v[202:203], v10 offset:13952
  v_mfma_f32_16x16x32_bf16 v[72:75], v[140:143], v[120:123], v[72:75]
  ds_read_b64_tr_b16 v[204:205], v11 offset:12416
  v_mfma_f32_16x16x32_bf16 v[76:79], v[140:143], v[124:127], v[76:79]
  ds_read_b64_tr_b16 v[206:207], v11 offset:13952
  v_mfma_f32_16x16x32_bf16 v[80:83], v[112:115], v[144:147], v[80:83]
  ds_read_b64_tr_b16 v[232:233], v10 offset:12544
  v_mfma_f32_16x16x32_bf16 v[84:87], v[112:115], v[148:151], v[84:87]
  ds_read_b64_tr_b16 v[234:235], v10 offset:14080
  v_mfma_f32_16x16x32_bf16 v[88:91], v[116:119], v[144:147], v[88:91]
  ds_read_b64_tr_b16 v[236:237], v11 offset:12544
  v_mfma_f32_16x16x32_bf16 v[92:95], v[116:119], v[148:151], v[92:95]
  ds_read_b64_tr_b16 v[238:239], v11 offset:14080
  v_mfma_f32_16x16x32_bf16 v[96:99], v[120:123], v[144:147], v[96:99]
  v_add_u32 v12, 122880, v2
  v_mfma_f32_16x16x32_bf16 v[100:103], v[120:123], v[148:151], v[100:103]
  v_add_u32 v13, 122880, v3
  v_mfma_f32_16x16x32_bf16 v[104:107], v[124:127], v[144:147], v[104:107]
  v_add_u32 v14, 122880, v4
  v_mfma_f32_16x16x32_bf16 v[108:111], v[124:127], v[148:151], v[108:111]
  v_add_u32 v15, 122880, v5
  s_waitcnt lgkmcnt(4)
  v_mfma_f32_16x16x32_bf16 v[48:51], v[200:203], v[152:155], v[48:51]
  ds_read_b64_tr_b16 v[136:137], v10 offset:12288
  v_mfma_f32_16x16x32_bf16 v[52:55], v[200:203], v[156:159], v[52:55]
  ds_read_b64_tr_b16 v[138:139], v10 offset:13824
  v_mfma_f32_16x16x32_bf16 v[56:59], v[200:203], v[160:163], v[56:59]
  ds_read_b64_tr_b16 v[140:141], v11 offset:12288
  v_mfma_f32_16x16x32_bf16 v[60:63], v[200:203], v[164:167], v[60:63]
  ds_read_b64_tr_b16 v[142:143], v11 offset:13824
  v_mfma_f32_16x16x32_bf16 v[64:67], v[204:207], v[152:155], v[64:67]
  v_mfma_f32_16x16x32_bf16 v[68:71], v[204:207], v[156:159], v[68:71]
  v_mfma_f32_16x16x32_bf16 v[72:75], v[204:207], v[160:163], v[72:75]
  v_mfma_f32_16x16x32_bf16 v[76:79], v[204:207], v[164:167], v[76:79]
  s_waitcnt lgkmcnt(4)
  v_mfma_f32_16x16x32_bf16 v[80:83], v[152:155], v[232:235], v[80:83]
  s_barrier
  v_mfma_f32_16x16x32_bf16 v[84:87], v[152:155], v[236:239], v[84:87]
  ds_read_b128 v[168:171], v12 offset:0
  ds_read_b128 v[172:175], v12 offset:2048
  v_mfma_f32_16x16x32_bf16 v[88:91], v[156:159], v[232:235], v[88:91]
  ds_read_b128 v[176:179], v12 offset:4096
  v_mfma_f32_16x16x32_bf16 v[92:95], v[156:159], v[236:239], v[92:95]
  ds_read_b128 v[180:183], v12 offset:6144
  v_mfma_f32_16x16x32_bf16 v[96:99], v[160:163], v[232:235], v[96:99]
  ds_read_b64_tr_b16 v[144:145], v14 offset:128
  v_mfma_f32_16x16x32_bf16 v[100:103], v[160:163], v[236:239], v[100:103]
  ds_read_b64_tr_b16 v[146:147], v14 offset:1664
  v_mfma_f32_16x16x32_bf16 v[104:107], v[164:167], v[232:235], v[104:107]
  ds_read_b64_tr_b16 v[148:149], v15 offset:128
  v_mfma_f32_16x16x32_bf16 v[108:111], v[164:167], v[236:239], v[108:111]
  ds_read_b64_tr_b16 v[150:151], v15 offset:1664
  v_mfma_f32_16x16x32_bf16 v[16:19], v[128:131], v[112:115], v[16:19]
  ds_read_b128 v[184:187], v13 offset:0
  v_mfma_f32_16x16x32_bf16 v[20:23], v[128:131], v[116:119], v[20:23]
  ds_read_b128 v[188:191], v13 offset:2048
  v_mfma_f32_16x16x32_bf16 v[24:27], v[128:131], v[120:123], v[24:27]
  ds_read_b128 v[192:195], v13 offset:4096
  v_mfma_f32_16x16x32_bf16 v[28:31], v[128:131], v[124:127], v[28:31]
  ds_read_b128 v[196:199], v13 offset:6144
  v_mfma_f32_16x16x32_bf16 v[32:35], v[132:135], v[112:115], v[32:35]
  ds_read_b64_tr_b16 v[200:201], v14 offset:12416
  v_mfma_f32_16x16x32_bf16 v[36:39], v[132:135], v[116:119], v[36:39]
  ds_read_b64_tr_b16 v[202:203], v14 offset:13952
  v_mfma_f32_16x16x32_bf16 v[40:43], v[132:135], v[120:123], v[40:43]
  ds_read_b64_tr_b16 v[204:205], v15 offset:12416
  v_mfma_f32_16x16x32_bf16 v[44:47], v[132:135], v[124:127], v[44:47]
  ds_read_b64_tr_b16 v[206:207], v15 offset:13952
  s_waitcnt lgkmcnt(8)
  v_mfma_f32_16x16x32_bf16 v[48:51], v[144:147], v[168:171], v[48:51]
  ds_read_b64_tr_b16 v[232:233], v14 offset:256
  v_mfma_f32_16x16x32_bf16 v[52:55], v[144:147], v[172:175], v[52:55]
  ds_read_b64_tr_b16 v[234:235], v14 offset:1792
  v_mfma_f32_16x16x32_bf16 v[56:59], v[144:147], v[176:179], v[56:59]
  ds_read_b64_tr_b16 v[236:237], v15 offset:256
  v_mfma_f32_16x16x32_bf16 v[60:63], v[144:147], v[180:183], v[60:63]
  ds_read_b64_tr_b16 v[238:239], v15 offset:1792
  v_mfma_f32_16x16x32_bf16 v[64:67], v[148:151], v[168:171], v[64:67]
  v_mfma_f32_16x16x32_bf16 v[68:71], v[148:151], v[172:175], v[68:71]
  v_mfma_f32_16x16x32_bf16 v[72:75], v[148:151], v[176:179], v[72:75]
  v_mfma_f32_16x16x32_bf16 v[76:79], v[148:151], v[180:183], v[76:79]
  s_waitcnt lgkmcnt(4)
  v_mfma_f32_16x16x32_bf16 v[48:51], v[200:203], v[184:187], v[48:51]
  ds_read_b64_tr_b16 v[128:129], v14 offset:12544
  v_mfma_f32_16x16x32_bf16 v[52:55], v[200:203], v[188:191], v[52:55]
  ds_read_b64_tr_b16 v[130:131], v14 offset:14080
  v_mfma_f32_16x16x32_bf16 v[56:59], v[200:203], v[192:195], v[56:59]
  ds_read_b64_tr_b16 v[132:133], v15 offset:12544
  v_mfma_f32_16x16x32_bf16 v[60:63], v[200:203], v[196:199], v[60:63]
  ds_read_b64_tr_b16 v[134:135], v15 offset:14080
  v_mfma_f32_16x16x32_bf16 v[64:67], v[204:207], v[184:187], v[64:67]
  v_mfma_f32_16x16x32_bf16 v[68:71], v[204:207], v[188:191], v[68:71]
  v_mfma_f32_16x16x32_bf16 v[72:75], v[204:207], v[192:195], v[72:75]
  v_mfma_f32_16x16x32_bf16 v[76:79], v[204:207], v[196:199], v[76:79]
  s_waitcnt lgkmcnt(4)
  v_mfma_f32_16x16x32_bf16 v[80:83], v[168:171], v[232:235], v[80:83]
  ds_read_b64_tr_b16 v[144:145], v14 offset:0
  v_mfma_f32_16x16x32_bf16 v[84:87], v[168:171], v[236:239], v[84:87]
  ds_read_b64_tr_b16 v[146:147], v14 offset:1536
  v_cvt_pk_bf16_f32 v48, v48, v49
  v_cvt_pk_bf16_f32 v49, v50, v51
  v_cvt_pk_bf16_f32 v50, v52, v53
  v_cvt_pk_bf16_f32 v51, v54, v55
  v_mfma_f32_16x16x32_bf16 v[88:91], v[172:175], v[232:235], v[88:91]
  ds_read_b64_tr_b16 v[148:149], v15 offset:0
  v_permlane16_swap_b32 v48, v50
  v_permlane16_swap_b32 v49, v51
  buffer_store_dwordx4 v[48:51], v212, s[12:15], s39 offen offset:0
  v_mfma_f32_16x16x32_bf16 v[92:95], v[172:175], v[236:239], v[92:95]
  ds_read_b64_tr_b16 v[150:151], v15 offset:1536
  v_cvt_pk_bf16_f32 v56, v56, v57
  v_cvt_pk_bf16_f32 v57, v58, v59
  v_cvt_pk_bf16_f32 v58, v60, v61
  v_cvt_pk_bf16_f32 v59, v62, v63
  v_mfma_f32_16x16x32_bf16 v[96:99], v[176:179], v[232:235], v[96:99]
  v_permlane16_swap_b32 v56, v58
  v_permlane16_swap_b32 v57, v59
  buffer_store_dwordx4 v[56:59], v212, s[12:15], s39 offen offset:1024
  v_mfma_f32_16x16x32_bf16 v[100:103], v[176:179], v[236:239], v[100:103]
  v_cvt_pk_bf16_f32 v64, v64, v65
  v_cvt_pk_bf16_f32 v65, v66, v67
  v_cvt_pk_bf16_f32 v66, v68, v69
  v_cvt_pk_bf16_f32 v67, v70, v71
  v_mfma_f32_16x16x32_bf16 v[104:107], v[180:183], v[232:235], v[104:107]
  v_permlane16_swap_b32 v64, v66
  v_permlane16_swap_b32 v65, v67
  buffer_store_dwordx4 v[64:67], v213, s[12:15], s39 offen offset:0
  v_mfma_f32_16x16x32_bf16 v[108:111], v[180:183], v[236:239], v[108:111]
  v_cvt_pk_bf16_f32 v72, v72, v73
  v_cvt_pk_bf16_f32 v73, v74, v75
  v_cvt_pk_bf16_f32 v74, v76, v77
  v_cvt_pk_bf16_f32 v75, v78, v79
  s_waitcnt lgkmcnt(4)
  v_mfma_f32_16x16x32_bf16 v[80:83], v[184:187], v[128:131], v[80:83]
  v_permlane16_swap_b32 v72, v74
  v_permlane16_swap_b32 v73, v75
  buffer_store_dwordx4 v[72:75], v213, s[12:15], s39 offen offset:1024
  v_mfma_f32_16x16x32_bf16 v[84:87], v[184:187], v[132:135], v[84:87]
  ds_read_b64_tr_b16 v[200:201], v14 offset:12288
  v_mfma_f32_16x16x32_bf16 v[88:91], v[188:191], v[128:131], v[88:91]
  ds_read_b64_tr_b16 v[202:203], v14 offset:13824
  v_mfma_f32_16x16x32_bf16 v[92:95], v[188:191], v[132:135], v[92:95]
  ds_read_b64_tr_b16 v[204:205], v15 offset:12288
  v_mfma_f32_16x16x32_bf16 v[96:99], v[192:195], v[128:131], v[96:99]
  ds_read_b64_tr_b16 v[206:207], v15 offset:13824
  v_mfma_f32_16x16x32_bf16 v[100:103], v[192:195], v[132:135], v[100:103]
  v_mfma_f32_16x16x32_bf16 v[104:107], v[196:199], v[128:131], v[104:107]
  v_mfma_f32_16x16x32_bf16 v[108:111], v[196:199], v[132:135], v[108:111]
  s_waitcnt lgkmcnt(0)
  s_barrier
  v_mfma_f32_16x16x32_bf16 v[16:19], v[136:139], v[152:155], v[16:19]
  v_mfma_f32_16x16x32_bf16 v[20:23], v[136:139], v[156:159], v[20:23]
  v_cvt_pk_bf16_f32 v80, v80, v81
  v_cvt_pk_bf16_f32 v81, v82, v83
  v_cvt_pk_bf16_f32 v82, v84, v85
  v_cvt_pk_bf16_f32 v83, v86, v87
  v_mfma_f32_16x16x32_bf16 v[24:27], v[136:139], v[160:163], v[24:27]
  v_permlane16_swap_b32 v80, v82
  v_permlane16_swap_b32 v81, v83
  buffer_store_dwordx4 v[80:83], v214, s[12:15], s40 offen offset:0
  v_mfma_f32_16x16x32_bf16 v[28:31], v[136:139], v[164:167], v[28:31]
  v_cvt_pk_bf16_f32 v88, v88, v89
  v_cvt_pk_bf16_f32 v89, v90, v91
  v_cvt_pk_bf16_f32 v90, v92, v93
  v_cvt_pk_bf16_f32 v91, v94, v95
  v_mfma_f32_16x16x32_bf16 v[32:35], v[140:143], v[152:155], v[32:35]
  v_permlane16_swap_b32 v88, v90
  v_permlane16_swap_b32 v89, v91
  buffer_store_dwordx4 v[88:91], v214, s[12:15], s40 offen offset:512
  v_mfma_f32_16x16x32_bf16 v[36:39], v[140:143], v[156:159], v[36:39]
  v_cvt_pk_bf16_f32 v96, v96, v97
  v_cvt_pk_bf16_f32 v97, v98, v99
  v_cvt_pk_bf16_f32 v98, v100, v101
  v_cvt_pk_bf16_f32 v99, v102, v103
  v_mfma_f32_16x16x32_bf16 v[40:43], v[140:143], v[160:163], v[40:43]
  v_permlane16_swap_b32 v96, v98
  v_permlane16_swap_b32 v97, v99
  buffer_store_dwordx4 v[96:99], v214, s[12:15], s40 offen offset:1024
  v_mfma_f32_16x16x32_bf16 v[44:47], v[140:143], v[164:167], v[44:47]
  v_cvt_pk_bf16_f32 v104, v104, v105
  v_cvt_pk_bf16_f32 v105, v106, v107
  v_cvt_pk_bf16_f32 v106, v108, v109
  v_cvt_pk_bf16_f32 v107, v110, v111
  v_mfma_f32_16x16x32_bf16 v[16:19], v[144:147], v[168:171], v[16:19]
  v_permlane16_swap_b32 v104, v106
  v_permlane16_swap_b32 v105, v107
  buffer_store_dwordx4 v[104:107], v214, s[12:15], s40 offen offset:1536
  v_mfma_f32_16x16x32_bf16 v[20:23], v[144:147], v[172:175], v[20:23]
  v_mfma_f32_16x16x32_bf16 v[24:27], v[144:147], v[176:179], v[24:27]
  v_mfma_f32_16x16x32_bf16 v[28:31], v[144:147], v[180:183], v[28:31]
  v_mfma_f32_16x16x32_bf16 v[32:35], v[148:151], v[168:171], v[32:35]
  v_mfma_f32_16x16x32_bf16 v[36:39], v[148:151], v[172:175], v[36:39]
  v_mfma_f32_16x16x32_bf16 v[40:43], v[148:151], v[176:179], v[40:43]
  v_mfma_f32_16x16x32_bf16 v[44:47], v[148:151], v[180:183], v[44:47]
  v_mfma_f32_16x16x32_bf16 v[16:19], v[200:203], v[184:187], v[16:19]
  v_mfma_f32_16x16x32_bf16 v[20:23], v[200:203], v[188:191], v[20:23]
  v_mfma_f32_16x16x32_bf16 v[24:27], v[200:203], v[192:195], v[24:27]
  v_mfma_f32_16x16x32_bf16 v[28:31], v[200:203], v[196:199], v[28:31]
  v_mfma_f32_16x16x32_bf16 v[32:35], v[204:207], v[184:187], v[32:35]
  v_mfma_f32_16x16x32_bf16 v[36:39], v[204:207], v[188:191], v[36:39]
  v_mfma_f32_16x16x32_bf16 v[40:43], v[204:207], v[192:195], v[40:43]
  v_mfma_f32_16x16x32_bf16 v[44:47], v[204:207], v[196:199], v[44:47]
  s_mov_b32 s58, 0
  s_nop 1
  v_pk_mul_f32 v[16:17], v[16:17], s[36:37]
  v_pk_mul_f32 v[18:19], v[18:19], s[36:37]
  v_pk_mul_f32 v[20:21], v[20:21], s[36:37]
  v_pk_mul_f32 v[22:23], v[22:23], s[36:37]
  v_cvt_pk_bf16_f32 v16, v16, v17
  v_cvt_pk_bf16_f32 v17, v18, v19
  v_cvt_pk_bf16_f32 v18, v20, v21
  v_cvt_pk_bf16_f32 v19, v22, v23
  s_nop 0
  v_permlane16_swap_b32 v16, v18
  v_permlane16_swap_b32 v17, v19
  buffer_store_dwordx4 v[16:19], v212, s[12:15], s38 offen offset:0
  v_pk_mul_f32 v[24:25], v[24:25], s[36:37]
  v_pk_mul_f32 v[26:27], v[26:27], s[36:37]
  v_pk_mul_f32 v[28:29], v[28:29], s[36:37]
  v_pk_mul_f32 v[30:31], v[30:31], s[36:37]
  v_cvt_pk_bf16_f32 v24, v24, v25
  v_cvt_pk_bf16_f32 v25, v26, v27
  v_cvt_pk_bf16_f32 v26, v28, v29
  v_cvt_pk_bf16_f32 v27, v30, v31
  s_nop 0
  v_permlane16_swap_b32 v24, v26
  v_permlane16_swap_b32 v25, v27
  buffer_store_dwordx4 v[24:27], v212, s[12:15], s38 offen offset:1024
  v_pk_mul_f32 v[32:33], v[32:33], s[36:37]
  v_pk_mul_f32 v[34:35], v[34:35], s[36:37]
  v_pk_mul_f32 v[36:37], v[36:37], s[36:37]
  v_pk_mul_f32 v[38:39], v[38:39], s[36:37]
  v_cvt_pk_bf16_f32 v32, v32, v33
  v_cvt_pk_bf16_f32 v33, v34, v35
  v_cvt_pk_bf16_f32 v34, v36, v37
  v_cvt_pk_bf16_f32 v35, v38, v39
  s_nop 0
  v_permlane16_swap_b32 v32, v34
  v_permlane16_swap_b32 v33, v35
  buffer_store_dwordx4 v[32:35], v213, s[12:15], s38 offen offset:0
  v_pk_mul_f32 v[40:41], v[40:41], s[36:37]
  v_pk_mul_f32 v[42:43], v[42:43], s[36:37]
  v_pk_mul_f32 v[44:45], v[44:45], s[36:37]
  v_pk_mul_f32 v[46:47], v[46:47], s[36:37]
  v_cvt_pk_bf16_f32 v40, v40, v41
  v_cvt_pk_bf16_f32 v41, v42, v43
  v_cvt_pk_bf16_f32 v42, v44, v45
  v_cvt_pk_bf16_f32 v43, v46, v47
  s_nop 0
  v_permlane16_swap_b32 v40, v42
  v_permlane16_swap_b32 v41, v43
  buffer_store_dwordx4 v[40:43], v213, s[12:15], s38 offen offset:1024
  v_lshlrev_b32 v5, 4, v0
  v_mov_b32 v2, v5
  v_and_b32 v1, 15, v0
  v_lshrrev_b32 v6, 5, v0
  v_lshl_or_b32 v1, v6, 4, v1
  v_lshlrev_b32 v1, 4, v1
  v_add_u32 v3, 65536, v1
  v_add_u32 v4, 66048, v1
  v_mov_b32 v1, 66560
  v_and_b32 v6, 27, v0
  v_cmp_ne_u32 vcc, 16, v6
  v_mov_b32 v6, 66576
  v_mov_b32 v7, 0xdddddddd
  v_cndmask_b32 v1, v1, v6, vcc
  v_and_b32 v6, 16, v0
  v_cmp_ne_u32 vcc, 0, v6
  v_mov_b32 v72, 0
  v_mov_b32 v73, 0
  v_cndmask_b32 v3, v3, v1, vcc
  v_cndmask_b32 v4, v4, v1, vcc
  s_lshl_b32 s27, s20, 12
  s_add_u32 s27, s27, 135168
  v_add_u32 v6, s27, v5
  v_mov_b64 v[74:75], 0
  v_mov_b64 v[76:77], 0
  v_mov_b64 v[78:79], 0
  v_mov_b64 v[44:45], 0
  v_mov_b64 v[46:47], 0
  v_mov_b64 v[80:81], 0
  v_mov_b64 v[82:83], 0
  v_mov_b64 v[84:85], 0
  v_mov_b64 v[86:87], 0
  v_mov_b64 v[88:89], 0
  v_mov_b64 v[90:91], 0
  v_mov_b64 v[92:93], 0
  v_mov_b64 v[94:95], 0
  v_mov_b64 v[96:97], 0
  v_mov_b64 v[98:99], 0
  v_mov_b64 v[100:101], 0
  v_mov_b64 v[102:103], 0
  v_mov_b64 v[104:105], 0
  v_mov_b64 v[106:107], 0
  v_mov_b64 v[108:109], 0
  v_mov_b64 v[110:111], 0
  v_mov_b64 v[112:113], 0
  v_mov_b64 v[114:115], 0
  v_mov_b64 v[116:117], 0
  v_mov_b64 v[118:119], 0
  v_mov_b64 v[120:121], 0
  v_mov_b64 v[122:123], 0
  v_mov_b64 v[124:125], 0
  v_mov_b64 v[126:127], 0
  v_mov_b64 v[128:129], 0
  v_mov_b64 v[130:131], 0
  v_mov_b64 v[132:133], 0
  v_mov_b64 v[134:135], 0
  v_mov_b64 v[136:137], 0
  v_mov_b64 v[138:139], 0
  v_mov_b64 v[140:141], 0
  v_mov_b64 v[142:143], 0
  s_lshr_b32 s27, s22, 3
  s_lshl_b32 s27, s27, 2
  s_add_u32 s27, s27, s20
  s_lshl_b32 s28, s23, 4
  s_add_u32 s27, s27, s28
  s_lshl_b32 s28, s24, 3
  s_and_b32 s29, s22, 7
  s_add_u32 s28, s28, s29
  s_lshl_b32 s33, s27, 17
  s_lshl_b32 s29, s28, 10
  s_add_u32 s33, s33, s29
  s_add_u32 s33, s33, 12582912
  s_lshl_b32 s55, s27, 8
  s_lshl_b32 s29, s28, 3
  s_add_u32 s55, s55, s29
  s_add_u32 s55, s55, 16785408
  s_mov_b32 s35, 0
  s_mov_b32 s54, 0
L1_census:
  s_waitcnt vmcnt(0)
  v_readfirstlane_b32 s56, v224
  v_readfirstlane_b32 s57, v225
  s_cmp_eq_u32 s56, 0
  s_cbranch_scc1 L1_cspin
  s_cmp_eq_u32 s44, 0
  s_cbranch_scc1 L1_report
L1_reported:
  v_cmp_ne_u64 vcc, v[224:225], v[228:229]
  s_cbranch_vccnz L1_cspin
L1_cdone:
  v_cmp_ne_u32 vcc, s46, v230
  s_nop 1
  s_cmp_eq_u64 vcc, 0
  s_cselect_b32 s59, 1, 0
  s_mov_b64 exec, 1
  s_cbranch_scc0 L1_slowrel
  buffer_store_dwordx2 v[224:225], v220, s[12:15], s42 offen
L1_reldone:
  s_mov_b64 exec, -1
  s_branch L2_page
.p2align 12
L2_page:
  s_cmp_eq_u32 s53, 1
  s_cbranch_scc1 L1_touched
  s_barrier
  ds_read_b128 v[8:11], v6 offset:0
  ds_read_b128 v[12:15], v6 offset:1024
  ds_read_b128 v[16:19], v6 offset:2048
  ds_read_b128 v[20:23], v6 offset:3072
  ds_read_b128 v[24:27], v2
  ds_read_b128 v[32:35], v3
  ds_read_b128 v[36:39], v4
  s_mov_b64 exec, -1
  s_waitcnt lgkmcnt(0)
  v_mfma_f32_32x32x16_bf16 v[48:63], v[24:27], v[8:11], 0
  s_nop 7
  s_nop 3
.p2align 3
L2_loop:
  v_exp_f32 v48, v48
  v_exp_f32 v49, v49
  v_smfmac_f32_32x32x32_bf16 v[128:143], v[44:47], v[72:79], v7
  ds_read_b128 v[28:31], v2 offset:1024
  v_exp_f32 v50, v50
  v_exp_f32 v51, v51
  v_exp_f32 v52, v52
  v_mfma_f32_32x32x16_bf16 v[64:79], v[24:27], v[12:15], 0
  ds_read_b128 v[40:43], v3 offset:1056
  v_exp_f32 v53, v53
  v_exp_f32 v54, v54
  v_exp_f32 v55, v55
  v_exp_f32 v56, v56
  v_exp_f32 v57, v57
  v_smfmac_f32_32x32x32_bf16 v[80:95], v[32:35], v[48:55], v7
  ds_read_b128 v[44:47], v4 offset:1056
  v_exp_f32 v58, v58
  v_exp_f32 v59, v59
  v_exp_f32 v60, v60
  v_exp_f32 v61, v61
  v_exp_f32 v62, v62
  v_exp_f32 v63, v63
  v_exp_f32 v64, v64
  v_exp_f32 v65, v65
  v_smfmac_f32_32x32x32_bf16 v[80:95], v[36:39], v[56:63], v7
  v_exp_f32 v66, v66
  v_exp_f32 v67, v67
  v_exp_f32 v68, v68
  v_mfma_f32_32x32x16_bf16 v[48:63], v[24:27], v[16:19], 0
  v_exp_f32 v69, v69
  v_exp_f32 v70, v70
  v_exp_f32 v71, v71
  v_exp_f32 v72, v72
  v_exp_f32 v73, v73
  v_smfmac_f32_32x32x32_bf16 v[96:111], v[32:35], v[64:71], v7
  v_exp_f32 v74, v74
  v_exp_f32 v75, v75
  v_exp_f32 v76, v76
  v_exp_f32 v77, v77
  v_exp_f32 v78, v78
  v_exp_f32 v79, v79
  v_exp_f32 v48, v48
  v_exp_f32 v49, v49
  v_smfmac_f32_32x32x32_bf16 v[96:111], v[36:39], v[72:79], v7
  v_exp_f32 v50, v50
  v_exp_f32 v51, v51
  v_exp_f32 v52, v52
  v_mfma_f32_32x32x16_bf16 v[64:79], v[24:27], v[20:23], 0
  v_exp_f32 v53, v53
  v_exp_f32 v54, v54
  v_exp_f32 v55, v55
  v_exp_f32 v56, v56
  v_exp_f32 v57, v57
  v_smfmac_f32_32x32x32_bf16 v[112:127], v[32:35], v[48:55], v7
  v_exp_f32 v58, v58
  v_exp_f32 v59, v59
  v_exp_f32 v60, v60
  v_exp_f32 v61, v61
  v_exp_f32 v62, v62
  v_exp_f32 v63, v63
  v_exp_f32 v64, v64
  v_exp_f32 v65, v65
  v_smfmac_f32_32x32x32_bf16 v[112:127], v[36:39], v[56:63], v7
  s_waitcnt lgkmcnt(0)
  v_exp_f32 v66, v66
  v_exp_f32 v67, v67
  v_exp_f32 v68, v68
  v_mfma_f32_32x32x16_bf16 v[48:63], v[28:31], v[8:11], 0
  v_exp_f32 v69, v69
  v_exp_f32 v70, v70
  v_exp_f32 v71, v71
  v_exp_f32 v72, v72
  v_exp_f32 v73, v73
  v_smfmac_f32_32x32x32_bf16 v[128:143], v[32:35], v[64:71], v7
  v_exp_f32 v74, v74
  v_exp_f32 v75, v75
  v_exp_f32 v76, v76
  v_exp_f32 v77, v77
  v_exp_f32 v78, v78
  v_exp_f32 v79, v79
  v_exp_f32 v48, v48
  v_exp_f32 v49, v49
  v_smfmac_f32_32x32x32_bf16 v[128:143], v[36:39], v[72:79], v7
  ds_read_b128 v[24:27], v2 offset:2048
  v_exp_f32 v50, v50
  v_exp_f32 v51, v51
  v_exp_f32 v52, v52
  v_mfma_f32_32x32x16_bf16 v[64:79], v[28:31], v[12:15], 0
  ds_read_b128 v[32:35], v3 offset:2112
  v_exp_f32 v53, v53
  v_exp_f32 v54, v54
  v_exp_f32 v55, v55
  v_exp_f32 v56, v56
  v_exp_f32 v57, v57
  v_smfmac_f32_32x32x32_bf16 v[80:95], v[40:43], v[48:55], v7
  ds_read_b128 v[36:39], v4 offset:2112
  v_exp_f32 v58, v58
  v_exp_f32 v59, v59
  v_exp_f32 v60, v60
  v_exp_f32 v61, v61
  v_exp_f32 v62, v62
  v_exp_f32 v63, v63
  v_exp_f32 v64, v64
  v_exp_f32 v65, v65
  v_smfmac_f32_32x32x32_bf16 v[80:95], v[44:47], v[56:63], v7
  v_exp_f32 v66, v66
  v_exp_f32 v67, v67
  v_exp_f32 v68, v68
  v_mfma_f32_32x32x16_bf16 v[48:63], v[28:31], v[16:19], 0
  v_exp_f32 v69, v69
  v_exp_f32 v70, v70
  v_exp_f32 v71, v71
  v_exp_f32 v72, v72
  v_exp_f32 v73, v73
  v_smfmac_f32_32x32x32_bf16 v[96:111], v[40:43], v[64:71], v7
  v_exp_f32 v74, v74
  v_exp_f32 v75, v75
  v_exp_f32 v76, v76
  v_exp_f32 v77, v77
  v_exp_f32 v78, v78
  v_exp_f32 v79, v79
  v_exp_f32 v48, v48
  v_exp_f32 v49, v49
  v_smfmac_f32_32x32x32_bf16 v[96:111], v[44:47], v[72:79], v7
  v_exp_f32 v50, v50
  v_exp_f32 v51, v51
  v_exp_f32 v52, v52
  v_mfma_f32_32x32x16_bf16 v[64:79], v[28:31], v[20:23], 0
  v_exp_f32 v53, v53
  v_exp_f32 v54, v54
  v_exp_f32 v55, v55
  v_exp_f32 v56, v56
  v_exp_f32 v57, v57
  v_smfmac_f32_32x32x32_bf16 v[112:127], v[40:43], v[48:55], v7
  v_exp_f32 v58, v58
  v_exp_f32 v59, v59
  v_exp_f32 v60, v60
  v_exp_f32 v61, v61
  v_exp_f32 v62, v62
  v_exp_f32 v63, v63
  v_exp_f32 v64, v64
  v_exp_f32 v65, v65
  v_smfmac_f32_32x32x32_bf16 v[112:127], v[44:47], v[56:63], v7
  s_waitcnt lgkmcnt(0)
  v_exp_f32 v66, v66
  v_exp_f32 v67, v67
  v_exp_f32 v68, v68
  v_mfma_f32_32x32x16_bf16 v[48:63], v[24:27], v[8:11], 0
  v_exp_f32 v69, v69
  v_exp_f32 v70, v70
  v_exp_f32 v71, v71
  v_exp_f32 v72, v72
  v_exp_f32 v73, v73
  v_smfmac_f32_32x32x32_bf16 v[128:143], v[40:43], v[64:71], v7
  v_exp_f32 v74, v74
  v_exp_f32 v75, v75
  v_exp_f32 v76, v76
  v_exp_f32 v77, v77
  v_exp_f32 v78, v78
  v_exp_f32 v79, v79
  v_exp_f32 v48, v48
  v_exp_f32 v49, v49
  v_smfmac_f32_32x32x32_bf16 v[128:143], v[44:47], v[72:79], v7
  ds_read_b128 v[28:31], v2 offset:3072
  v_exp_f32 v50, v50
  v_exp_f32 v51, v51
  v_exp_f32 v52, v52
  v_mfma_f32_32x32x16_bf16 v[64:79], v[24:27], v[12:15], 0
  ds_read_b128 v[40:43], v3 offset:3168
  v_exp_f32 v53, v53
  v_exp_f32 v54, v54
  v_exp_f32 v55, v55
  v_exp_f32 v56, v56
  v_exp_f32 v57, v57
  v_smfmac_f32_32x32x32_bf16 v[80:95], v[32:35], v[48:55], v7
  ds_read_b128 v[44:47], v4 offset:3168
  v_exp_f32 v58, v58
  v_exp_f32 v59, v59
  v_exp_f32 v60, v60
  v_exp_f32 v61, v61
  v_exp_f32 v62, v62
  v_exp_f32 v63, v63
  v_exp_f32 v64, v64
  v_exp_f32 v65, v65
  v_smfmac_f32_32x32x32_bf16 v[80:95], v[36:39], v[56:63], v7
  v_exp_f32 v66, v66
  v_exp_f32 v67, v67
  v_exp_f32 v68, v68
  v_mfma_f32_32x32x16_bf16 v[48:63], v[24:27], v[16:19], 0
  v_exp_f32 v69, v69
  v_exp_f32 v70, v70
  v_exp_f32 v71, v71
  v_exp_f32 v72, v72
  v_exp_f32 v73, v73
  v_smfmac_f32_32x32x32_bf16 v[96:111], v[32:35], v[64:71], v7
  v_exp_f32 v74, v74
  v_exp_f32 v75, v75
  v_exp_f32 v76, v76
  v_exp_f32 v77, v77
  v_exp_f32 v78, v78
  v_exp_f32 v79, v79
  v_exp_f32 v48, v48
  v_exp_f32 v49, v49
  v_smfmac_f32_32x32x32_bf16 v[96:111], v[36:39], v[72:79], v7
  v_exp_f32 v50, v50
  v_exp_f32 v51, v51
  v_exp_f32 v52, v52
  v_mfma_f32_32x32x16_bf16 v[64:79], v[24:27], v[20:23], 0
  v_exp_f32 v53, v53
  v_exp_f32 v54, v54
  v_exp_f32 v55, v55
  v_exp_f32 v56, v56
  v_exp_f32 v57, v57
  v_smfmac_f32_32x32x32_bf16 v[112:127], v[32:35], v[48:55], v7
  v_exp_f32 v58, v58
  v_exp_f32 v59, v59
  v_exp_f32 v60, v60
  v_exp_f32 v61, v61
  v_exp_f32 v62, v62
  v_exp_f32 v63, v63
  v_exp_f32 v64, v64
  v_exp_f32 v65, v65
  v_smfmac_f32_32x32x32_bf16 v[112:127], v[36:39], v[56:63], v7
  s_waitcnt lgkmcnt(0)
  v_exp_f32 v66, v66
  v_exp_f32 v67, v67
  v_exp_f32 v68, v68
  v_mfma_f32_32x32x16_bf16 v[48:63], v[28:31], v[8:11], 0
  v_exp_f32 v69, v69
  v_exp_f32 v70, v70
  v_exp_f32 v71, v71
  v_exp_f32 v72, v72
  v_exp_f32 v73, v73
  v_smfmac_f32_32x32x32_bf16 v[128:143], v[32:35], v[64:71], v7
  v_exp_f32 v74, v74
  v_exp_f32 v75, v75
  v_exp_f32 v76, v76
  v_exp_f32 v77, v77
  v_exp_f32 v78, v78
  v_exp_f32 v79, v79
  v_exp_f32 v48, v48
  v_exp_f32 v49, v49
  v_smfmac_f32_32x32x32_bf16 v[128:143], v[36:39], v[72:79], v7
  ds_read_b128 v[24:27], v2 offset:4096
  v_exp_f32 v50, v50
  v_exp_f32 v51, v51
  v_exp_f32 v52, v52
  v_mfma_f32_32x32x16_bf16 v[64:79], v[28:31], v[12:15], 0
  ds_read_b128 v[32:35], v3 offset:4224
  v_exp_f32 v53, v53
  v_exp_f32 v54, v54
  v_exp_f32 v55, v55
  v_exp_f32 v56, v56
  v_exp_f32 v57, v57
  v_smfmac_f32_32x32x32_bf16 v[80:95], v[40:43], v[48:55], v7
  ds_read_b128 v[36:39], v4 offset:4224
  v_exp_f32 v58, v58
  v_exp_f32 v59, v59
  v_exp_f32 v60, v60
  v_exp_f32 v61, v61
  v_exp_f32 v62, v62
  v_exp_f32 v63, v63
  v_exp_f32 v64, v64
  v_exp_f32 v65, v65
  v_smfmac_f32_32x32x32_bf16 v[80:95], v[44:47], v[56:63], v7
  v_exp_f32 v66, v66
  v_exp_f32 v67, v67
  v_exp_f32 v68, v68
  v_mfma_f32_32x32x16_bf16 v[48:63], v[28:31], v[16:19], 0
  v_exp_f32 v69, v69
  v_exp_f32 v70, v70
  v_exp_f32 v71, v71
  v_exp_f32 v72, v72
  v_exp_f32 v73, v73
  v_smfmac_f32_32x32x32_bf16 v[96:111], v[40:43], v[64:71], v7
  v_exp_f32 v74, v74
  v_exp_f32 v75, v75
  v_exp_f32 v76, v76
  v_exp_f32 v77, v77
  v_exp_f32 v78, v78
  v_exp_f32 v79, v79
  v_exp_f32 v48, v48
  v_exp_f32 v49, v49
  v_smfmac_f32_32x32x32_bf16 v[96:111], v[44:47], v[72:79], v7
  v_exp_f32 v50, v50
  v_exp_f32 v51, v51
  v_exp_f32 v52, v52
  v_mfma_f32_32x32x16_bf16 v[64:79], v[28:31], v[20:23], 0
  v_exp_f32 v53, v53
  v_exp_f32 v54, v54
  v_exp_f32 v55, v55
  v_exp_f32 v56, v56
  v_exp_f32 v57, v57
  v_smfmac_f32_32x32x32_bf16 v[112:127], v[40:43], v[48:55], v7
  v_exp_f32 v58, v58
  v_exp_f32 v59, v59
  v_exp_f32 v60, v60
  v_exp_f32 v61, v61
  v_exp_f32 v62, v62
  v_exp_f32 v63, v63
  v_exp_f32 v64, v64
  v_exp_f32 v65, v65
  v_smfmac_f32_32x32x32_bf16 v[112:127], v[44:47], v[56:63], v7
  s_waitcnt lgkmcnt(0)
  v_exp_f32 v66, v66
  v_exp_f32 v67, v67
  v_exp_f32 v68, v68
  v_mfma_f32_32x32x16_bf16 v[48:63], v[24:27], v[8:11], 0
  v_exp_f32 v69, v69
  v_exp_f32 v70, v70
  v_exp_f32 v71, v71
  v_exp_f32 v72, v72
  v_exp_f32 v73, v73
  v_smfmac_f32_32x32x32_bf16 v[128:143], v[40:43], v[64:71], v7
  v_exp_f32 v74, v74
  v_exp_f32 v75, v75
  v_exp_f32 v76, v76
  v_exp_f32 v77, v77
  v_exp_f32 v78, v78
  v_exp_f32 v79, v79
  v_exp_f32 v48, v48
  v_exp_f32 v49, v49
  v_smfmac_f32_32x32x32_bf16 v[128:143], v[44:47], v[72:79], v7
  ds_read_b128 v[28:31], v2 offset:5120
  v_exp_f32 v50, v50
  v_exp_f32 v51, v51
  v_exp_f32 v52, v52
  v_mfma_f32_32x32x16_bf16 v[64:79], v[24:27], v[12:15], 0
  ds_read_b128 v[40:43], v3 offset:5280
  v_exp_f32 v53, v53
  v_exp_f32 v54, v54
  v_exp_f32 v55, v55
  v_exp_f32 v56, v56
  v_exp_f32 v57, v57
  v_smfmac_f32_32x32x32_bf16 v[80:95], v[32:35], v[48:55], v7
  ds_read_b128 v[44:47], v4 offset:5280
  v_exp_f32 v58, v58
  v_exp_f32 v59, v59
  v_exp_f32 v60, v60
  v_exp_f32 v61, v61
  v_exp_f32 v62, v62
  v_exp_f32 v63, v63
  v_exp_f32 v64, v64
  v_exp_f32 v65, v65
  v_smfmac_f32_32x32x32_bf16 v[80:95], v[36:39], v[56:63], v7
  v_exp_f32 v66, v66
  v_exp_f32 v67, v67
  v_exp_f32 v68, v68
  v_mfma_f32_32x32x16_bf16 v[48:63], v[24:27], v[16:19], 0
  v_exp_f32 v69, v69
  v_exp_f32 v70, v70
  v_exp_f32 v71, v71
  v_exp_f32 v72, v72
  v_exp_f32 v73, v73
  v_smfmac_f32_32x32x32_bf16 v[96:111], v[32:35], v[64:71], v7
  v_exp_f32 v74, v74
  v_exp_f32 v75, v75
  v_exp_f32 v76, v76
  v_exp_f32 v77, v77
  v_exp_f32 v78, v78
  v_exp_f32 v79, v79
  v_exp_f32 v48, v48
  v_exp_f32 v49, v49
  v_smfmac_f32_32x32x32_bf16 v[96:111], v[36:39], v[72:79], v7
  v_exp_f32 v50, v50
  v_exp_f32 v51, v51
  v_exp_f32 v52, v52
  v_mfma_f32_32x32x16_bf16 v[64:79], v[24:27], v[20:23], 0
  v_exp_f32 v53, v53
  v_exp_f32 v54, v54
  v_exp_f32 v55, v55
  v_exp_f32 v56, v56
  v_exp_f32 v57, v57
  v_smfmac_f32_32x32x32_bf16 v[112:127], v[32:35], v[48:55], v7
  v_exp_f32 v58, v58
  v_exp_f32 v59, v59
  v_exp_f32 v60, v60
  v_exp_f32 v61, v61
  v_exp_f32 v62, v62
  v_exp_f32 v63, v63
  v_exp_f32 v64, v64
  v_exp_f32 v65, v65
  v_smfmac_f32_32x32x32_bf16 v[112:127], v[36:39], v[56:63], v7
  s_waitcnt lgkmcnt(0)
  v_exp_f32 v66, v66
  v_exp_f32 v67, v67
  v_exp_f32 v68, v68
  v_mfma_f32_32x32x16_bf16 v[48:63], v[28:31], v[8:11], 0
  v_exp_f32 v69, v69
  v_exp_f32 v70, v70
  v_exp_f32 v71, v71
  v_exp_f32 v72, v72
  v_exp_f32 v73, v73
  v_smfmac_f32_32x32x32_bf16 v[128:143], v[32:35], v[64:71], v7
  v_exp_f32 v74, v74
  v_exp_f32 v75, v75
  v_exp_f32 v76, v76
  v_exp_f32 v77, v77
  v_exp_f32 v78, v78
  v_exp_f32 v79, v79
  v_exp_f32 v48, v48
  v_exp_f32 v49, v49
  v_smfmac_f32_32x32x32_bf16 v[128:143], v[36:39], v[72:79], v7
  ds_read_b128 v[24:27], v2 offset:6144
  v_exp_f32 v50, v50
  v_exp_f32 v51, v51
  v_exp_f32 v52, v52
  v_mfma_f32_32x32x16_bf16 v[64:79], v[28:31], v[12:15], 0
  ds_read_b128 v[32:35], v3 offset:6336
  v_exp_f32 v53, v53
  v_exp_f32 v54, v54
  v_exp_f32 v55, v55
  v_exp_f32 v56, v56
  v_exp_f32 v57, v57
  v_smfmac_f32_32x32x32_bf16 v[80:95], v[40:43], v[48:55], v7
  ds_read_b128 v[36:39], v4 offset:6336
  v_exp_f32 v58, v58
  v_exp_f32 v59, v59
  v_exp_f32 v60, v60
  v_exp_f32 v61, v61
  v_exp_f32 v62, v62
  v_exp_f32 v63, v63
  v_exp_f32 v64, v64
  v_exp_f32 v65, v65
  v_smfmac_f32_32x32x32_bf16 v[80:95], v[44:47], v[56:63], v7
  v_exp_f32 v66, v66
  v_exp_f32 v67, v67
  v_exp_f32 v68, v68
  v_mfma_f32_32x32x16_bf16 v[48:63], v[28:31], v[16:19], 0
  v_exp_f32 v69, v69
  v_exp_f32 v70, v70
  v_exp_f32 v71, v71
  v_exp_f32 v72, v72
  v_exp_f32 v73, v73
  v_smfmac_f32_32x32x32_bf16 v[96:111], v[40:43], v[64:71], v7
  v_exp_f32 v74, v74
  v_exp_f32 v75, v75
  v_exp_f32 v76, v76
  v_exp_f32 v77, v77
  v_exp_f32 v78, v78
  v_exp_f32 v79, v79
  v_exp_f32 v48, v48
  v_exp_f32 v49, v49
  v_smfmac_f32_32x32x32_bf16 v[96:111], v[44:47], v[72:79], v7
  v_exp_f32 v50, v50
  v_exp_f32 v51, v51
  v_exp_f32 v52, v52
  v_mfma_f32_32x32x16_bf16 v[64:79], v[28:31], v[20:23], 0
  v_exp_f32 v53, v53
  v_exp_f32 v54, v54
  v_exp_f32 v55, v55
  v_exp_f32 v56, v56
  v_exp_f32 v57, v57
  v_smfmac_f32_32x32x32_bf16 v[112:127], v[40:43], v[48:55], v7
  v_exp_f32 v58, v58
  v_exp_f32 v59, v59
  v_exp_f32 v60, v60
  v_exp_f32 v61, v61
  v_exp_f32 v62, v62
  v_exp_f32 v63, v63
  v_exp_f32 v64, v64
  v_exp_f32 v65, v65
  v_smfmac_f32_32x32x32_bf16 v[112:127], v[44:47], v[56:63], v7
  s_waitcnt lgkmcnt(0)
  v_exp_f32 v66, v66
  v_exp_f32 v67, v67
  v_exp_f32 v68, v68
  v_mfma_f32_32x32x16_bf16 v[48:63], v[24:27], v[8:11], 0
  v_exp_f32 v69, v69
  v_exp_f32 v70, v70
  v_exp_f32 v71, v71
  v_exp_f32 v72, v72
  v_exp_f32 v73, v73
  v_smfmac_f32_32x32x32_bf16 v[128:143], v[40:43], v[64:71], v7
  v_exp_f32 v74, v74
  v_exp_f32 v75, v75
  v_exp_f32 v76, v76
  v_exp_f32 v77, v77
  v_exp_f32 v78, v78
  v_exp_f32 v79, v79
  v_exp_f32 v48, v48
  v_exp_f32 v49, v49
  v_smfmac_f32_32x32x32_bf16 v[128:143], v[44:47], v[72:79], v7
  ds_read_b128 v[28:31], v2 offset:7168
  v_exp_f32 v50, v50
  v_exp_f32 v51, v51
  v_exp_f32 v52, v52
  v_mfma_f32_32x32x16_bf16 v[64:79], v[24:27], v[12:15], 0
  ds_read_b128 v[40:43], v3 offset:7392
  v_exp_f32 v53, v53
  v_exp_f32 v54, v54
  v_exp_f32 v55, v55
  v_exp_f32 v56, v56
  v_exp_f32 v57, v57
  v_smfmac_f32_32x32x32_bf16 v[80:95], v[32:35], v[48:55], v7
  ds_read_b128 v[44:47], v4 offset:7392
  v_exp_f32 v58, v58
  v_exp_f32 v59, v59
  v_exp_f32 v60, v60
  v_exp_f32 v61, v61
  v_exp_f32 v62, v62
  v_exp_f32 v63, v63
  v_exp_f32 v64, v64
  v_exp_f32 v65, v65
  v_smfmac_f32_32x32x32_bf16 v[80:95], v[36:39], v[56:63], v7
  v_exp_f32 v66, v66
  v_exp_f32 v67, v67
  v_exp_f32 v68, v68
  v_mfma_f32_32x32x16_bf16 v[48:63], v[24:27], v[16:19], 0
  v_exp_f32 v69, v69
  v_exp_f32 v70, v70
  v_exp_f32 v71, v71
  v_exp_f32 v72, v72
  v_exp_f32 v73, v73
  v_smfmac_f32_32x32x32_bf16 v[96:111], v[32:35], v[64:71], v7
  v_exp_f32 v74, v74
  v_exp_f32 v75, v75
  v_exp_f32 v76, v76
  v_exp_f32 v77, v77
  v_exp_f32 v78, v78
  v_exp_f32 v79, v79
  v_exp_f32 v48, v48
  v_exp_f32 v49, v49
  v_smfmac_f32_32x32x32_bf16 v[96:111], v[36:39], v[72:79], v7
  v_exp_f32 v50, v50
  v_exp_f32 v51, v51
  v_exp_f32 v52, v52
  v_mfma_f32_32x32x16_bf16 v[64:79], v[24:27], v[20:23], 0
  v_exp_f32 v53, v53
  v_exp_f32 v54, v54
  v_exp_f32 v55, v55
  v_exp_f32 v56, v56
  v_exp_f32 v57, v57
  v_smfmac_f32_32x32x32_bf16 v[112:127], v[32:35], v[48:55], v7
  v_exp_f32 v58, v58
  v_exp_f32 v59, v59
  v_exp_f32 v60, v60
  v_exp_f32 v61, v61
  v_exp_f32 v62, v62
  v_exp_f32 v63, v63
  v_exp_f32 v64, v64
  v_exp_f32 v65, v65
  v_smfmac_f32_32x32x32_bf16 v[112:127], v[36:39], v[56:63], v7
  s_waitcnt lgkmcnt(0)
  v_exp_f32 v66, v66
  v_exp_f32 v67, v67
  v_exp_f32 v68, v68
  v_mfma_f32_32x32x16_bf16 v[48:63], v[28:31], v[8:11], 0
  v_exp_f32 v69, v69
  v_exp_f32 v70, v70
  v_exp_f32 v71, v71
  v_exp_f32 v72, v72
  v_exp_f32 v73, v73
  v_smfmac_f32_32x32x32_bf16 v[128:143], v[32:35], v[64:71], v7
  v_exp_f32 v74, v74
  v_exp_f32 v75, v75
  v_exp_f32 v76, v76
  v_exp_f32 v77, v77
  v_exp_f32 v78, v78
  v_exp_f32 v79, v79
  v_exp_f32 v48, v48
  v_exp_f32 v49, v49
  v_smfmac_f32_32x32x32_bf16 v[128:143], v[36:39], v[72:79], v7
  s_cmp_lg_u32 s35, 0
  s_cbranch_scc1 L2_skipw
  s_barrier
L2_skipw:
  ds_read_b128 v[24:27], v2 offset:8192
  v_exp_f32 v50, v50
  v_exp_f32 v51, v51
  v_exp_f32 v52, v52
  v_mfma_f32_32x32x16_bf16 v[64:79], v[28:31], v[12:15], 0
  ds_read_b128 v[32:35], v3 offset:8448
  v_exp_f32 v53, v53
  v_exp_f32 v54, v54
  v_exp_f32 v55, v55
  v_exp_f32 v56, v56
  v_exp_f32 v57, v57
  v_smfmac_f32_32x32x32_bf16 v[80:95], v[40:43], v[48:55], v7
  ds_read_b128 v[36:39], v4 offset:8448
  v_exp_f32 v58, v58
  v_exp_f32 v59, v59
  v_exp_f32 v60, v60
  v_exp_f32 v61, v61
  v_exp_f32 v62, v62
  v_exp_f32 v63, v63
  v_exp_f32 v64, v64
  v_exp_f32 v65, v65
  v_smfmac_f32_32x32x32_bf16 v[80:95], v[44:47], v[56:63], v7
  v_exp_f32 v66, v66
  v_exp_f32 v67, v67
  v_exp_f32 v68, v68
  v_mfma_f32_32x32x16_bf16 v[48:63], v[28:31], v[16:19], 0
  v_add_u32 v2, 8192, v2
  v_add_u32 v3, 8448, v3
  v_exp_f32 v69, v69
  v_exp_f32 v70, v70
  v_exp_f32 v71, v71
  v_exp_f32 v72, v72
  v_exp_f32 v73, v73
  v_smfmac_f32_32x32x32_bf16 v[96:111], v[40:43], v[64:71], v7
  v_exp_f32 v74, v74
  v_exp_f32 v75, v75
  v_exp_f32 v76, v76
  v_exp_f32 v77, v77
  v_exp_f32 v78, v78
  v_exp_f32 v79, v79
  v_exp_f32 v48, v48
  v_exp_f32 v49, v49
  v_smfmac_f32_32x32x32_bf16 v[96:111], v[44:47], v[72:79], v7
  v_exp_f32 v50, v50
  v_exp_f32 v51, v51
  v_exp_f32 v52, v52
  v_mfma_f32_32x32x16_bf16 v[64:79], v[28:31], v[20:23], 0
  v_add_u32 v4, 8448, v4
  s_add_u32 s35, s35, 1
  v_exp_f32 v53, v53
  v_exp_f32 v54, v54
  v_exp_f32 v55, v55
  v_exp_f32 v56, v56
  v_exp_f32 v57, v57
  v_smfmac_f32_32x32x32_bf16 v[112:127], v[40:43], v[48:55], v7
  v_exp_f32 v58, v58
  v_exp_f32 v59, v59
  v_exp_f32 v60, v60
  v_exp_f32 v61, v61
  v_exp_f32 v62, v62
  v_exp_f32 v63, v63
  v_exp_f32 v64, v64
  v_exp_f32 v65, v65
  v_smfmac_f32_32x32x32_bf16 v[112:127], v[44:47], v[56:63], v7
  s_waitcnt lgkmcnt(0)
  v_exp_f32 v66, v66
  v_exp_f32 v67, v67
  v_exp_f32 v68, v68
  v_mfma_f32_32x32x16_bf16 v[48:63], v[24:27], v[8:11], 0
  s_cmp_lt_u32 s35, 8
  v_exp_f32 v69, v69
  v_exp_f32 v70, v70
  v_exp_f32 v71, v71
  v_exp_f32 v72, v72
  v_exp_f32 v73, v73
  v_smfmac_f32_32x32x32_bf16 v[128:143], v[40:43], v[64:71], v7
  v_exp_f32 v74, v74
  v_exp_f32 v75, v75
  v_exp_f32 v76, v76
  v_exp_f32 v77, v77
  v_exp_f32 v78, v78
  v_exp_f32 v79, v79
  s_cbranch_scc1 L2_loop
  s_nop 1
  v_smfmac_f32_32x32x32_bf16 v[128:143], v[44:47], v[72:79], v7
  s_mov_b32 s36, 0x2f800000
  s_mov_b32 s37, 0x4f800000
  s_add_u32 s38, s33, 0x8000
  s_add_u32 s39, s33, 0x10000
  s_add_u32 s40, s33, 0x18000
L2_fin:
  v_rcp_f32 v48, v88
  v_rcp_f32 v50, v104
  v_rcp_f32 v52, v120
  v_pk_mul_f32 v[80:81], v[80:81], v[48:49] op_sel_hi:[1,0]
  v_pk_mul_f32 v[82:83], v[82:83], v[48:49] op_sel_hi:[1,0]
  v_pk_mul_f32 v[84:85], v[84:85], v[48:49] op_sel_hi:[1,0]
  v_pk_mul_f32 v[86:87], v[86:87], v[48:49] op_sel_hi:[1,0]
  v_cvt_pk_bf16_f32 v80, v80, v81
  v_cvt_pk_bf16_f32 v81, v82, v83
  v_cvt_pk_bf16_f32 v82, v84, v85
  v_cvt_pk_bf16_f32 v83, v86, v87
  buffer_store_dwordx4 v[80:83], v5, s[12:15], s33 offen sc1
  v_rcp_f32 v54, v136
  v_pk_mul_f32 v[96:97], v[96:97], v[50:51] op_sel_hi:[1,0]
  v_pk_mul_f32 v[98:99], v[98:99], v[50:51] op_sel_hi:[1,0]
  v_pk_mul_f32 v[100:101], v[100:101], v[50:51] op_sel_hi:[1,0]
  v_pk_mul_f32 v[102:103], v[102:103], v[50:51] op_sel_hi:[1,0]
  v_cvt_pk_bf16_f32 v96, v96, v97
  v_cvt_pk_bf16_f32 v97, v98, v99
  v_cvt_pk_bf16_f32 v98, v100, v101
  v_cvt_pk_bf16_f32 v99, v102, v103
  buffer_store_dwordx4 v[96:99], v5, s[12:15], s38 offen sc1
  v_pk_mul_f32 v[112:113], v[112:113], v[52:53] op_sel_hi:[1,0]
  v_pk_mul_f32 v[114:115], v[114:115], v[52:53] op_sel_hi:[1,0]
  v_pk_mul_f32 v[116:117], v[116:117], v[52:53] op_sel_hi:[1,0]
  v_pk_mul_f32 v[118:119], v[118:119], v[52:53] op_sel_hi:[1,0]
  v_cvt_pk_bf16_f32 v112, v112, v113
  v_cvt_pk_bf16_f32 v113, v114, v115
  v_cvt_pk_bf16_f32 v114, v116, v117
  v_cvt_pk_bf16_f32 v115, v118, v119
  buffer_store_dwordx4 v[112:115], v5, s[12:15], s39 offen sc1
  v_pk_mul_f32 v[128:129], v[128:129], v[54:55] op_sel_hi:[1,0]
  v_pk_mul_f32 v[130:131], v[130:131], v[54:55] op_sel_hi:[1,0]
  v_pk_mul_f32 v[132:133], v[132:133], v[54:55] op_sel_hi:[1,0]
  v_pk_mul_f32 v[134:135], v[134:135], v[54:55] op_sel_hi:[1,0]
  v_cvt_pk_bf16_f32 v128, v128, v129
  v_cvt_pk_bf16_f32 v129, v130, v131
  v_cvt_pk_bf16_f32 v130, v132, v133
  v_cvt_pk_bf16_f32 v131, v134, v135
  buffer_store_dwordx4 v[128:131], v5, s[12:15], s40 offen sc1
  s_cmp_lg_u32 s54, 0
  s_cbranch_scc1 L2_ok
  s_mov_b32 s27, 0x7f807f80
  v_min3_f32 v49, v88, v104, v120
  v_max3_f32 v50, v88, v104, v120
  v_add_f32 v51, v88, v104
  v_add_f32 v52, v120, v136
  v_min_f32 v49, v49, v136
  v_max_f32 v50, v50, v136
  v_add_f32 v51, v51, v52
  v_and_b32 v48, s27, v80
  v_and_b32 v53, s27, v81
  v_pk_max_u16 v48, v48, v53
  v_and_b32 v53, s27, v82
  v_pk_max_u16 v48, v48, v53
  v_and_b32 v53, s27, v83
  v_pk_max_u16 v48, v48, v53
  v_and_b32 v53, s27, v96
  v_pk_max_u16 v48, v48, v53
  v_and_b32 v53, s27, v97
  v_pk_max_u16 v48, v48, v53
  v_and_b32 v53, s27, v98
  v_pk_max_u16 v48, v48, v53
  v_and_b32 v53, s27, v99
  v_pk_max_u16 v48, v48, v53
  v_and_b32 v53, s27, v112
  v_pk_max_u16 v48, v48, v53
  v_and_b32 v53, s27, v113
  v_pk_max_u16 v48, v48, v53
  v_and_b32 v53, s27, v114
  v_pk_max_u16 v48, v48, v53
  v_and_b32 v53, s27, v115
  v_pk_max_u16 v48, v48, v53
  v_and_b32 v53, s27, v128
  v_pk_max_u16 v48, v48, v53
  v_and_b32 v53, s27, v129
  v_pk_max_u16 v48, v48, v53
  v_and_b32 v53, s27, v130
  v_pk_max_u16 v48, v48, v53
  v_and_b32 v53, s27, v131
  v_pk_max_u16 v48, v48, v53
  v_lshrrev_b32 v53, 16, v48
  v_and_b32 v48, 0xffff, v48
  v_max_u32 v48, v48, v53
  v_cmp_nge_f32 s[44:45], v49, s36
  v_cmp_nle_f32 s[46:47], v50, s37
  v_cmp_u_f32 s[48:49], v51, v51
  v_cmp_eq_u32 vcc, 0x7f80, v48
  s_nop 1
  s_or_b64 s[44:45], s[44:45], s[46:47]
  s_or_b64 vcc, vcc, s[48:49]
  s_or_b64 vcc, vcc, s[44:45]
  s_cbranch_vccnz L2_slow
L2_ok:
  s_load_dwordx2 s[10:11], s[0:1], 48
  s_lshl_b32 s27, s21, 2
  s_lshr_b32 s28, s22, 3
  s_add_u32 s27, s27, s28
  s_lshl_b32 s43, s27, 8
  s_add_u32 s43, s43, 16785408
  s_lshl_b32 s27, s27, 2
  s_add_u32 s27, s27, s20
  s_lshl_b32 s28, s27, 15
  s_add_u32 s28, s28, 12582912
  s_add_u32 s16, s18, s28
  s_addc_u32 s17, s19, 0
  s_mov_b32 s18, 32768
  s_mov_b32 s19, 0x20000
  v_mov_b32 v1, 0
  v_mov_b32 v26, s56
  v_mov_b32 v27, s57
  v_and_b32 v3, 31, v0
  v_lshlrev_b32 v3, 3, v3
  s_mov_b32 s58, 0
  s_waitcnt vmcnt(0)
  s_mov_b64 exec, 1
  buffer_store_dwordx2 v[26:27], v1, s[12:15], s55 offen sc1
  s_mov_b64 exec, -1
  s_branch L3_page
.p2align 12
L3_page:
  s_cmp_eq_u32 s53, 1
  s_cbranch_scc1 L1_touched
  s_barrier
  v_lshrrev_b32 v4, 5, v0
  v_bfe_u32 v2, v0, 2, 2
  v_lshl_add_u32 v2, v4, 2, v2
  v_lshlrev_b32 v6, 7, v2
  v_bfe_u32 v2, v0, 3, 1
  v_lshl_add_u32 v6, v2, 6, v6
  v_bfe_u32 v2, v0, 4, 1
  v_lshl_add_u32 v6, v2, 5, v6
  v_and_b32 v2, 1, v0
  v_lshl_add_u32 v6, v2, 4, v6
  v_bfe_u32 v2, v0, 1, 1
  v_lshl_add_u32 v6, v2, 3, v6
  v_xor_b32 v7, 64, v6
  v_and_b32 v2, 31, v0
  v_lshlrev_b32 v24, 11, v2
  v_lshl_add_u32 v24, v4, 4, v24
  s_and_b32 s30, s27, 63
  s_lshl_b32 s30, s30, 16
  s_lshl_b32 s31, s23, 10
  s_add_u32 s30, s30, s31
  s_and_b32 s31, s22, 7
  s_lshl_b32 s31, s31, 7
  s_add_u32 s30, s30, s31
  s_waitcnt lgkmcnt(0)
  s_mov_b32 s4, s10
  s_mov_b32 s5, s11
  s_mov_b32 s6, 4194304
  s_mov_b32 s7, 0x20000
  s_lshl_b32 s28, s20, 12
  s_add_u32 s28, s28, 65536
  v_and_b32 v2, 31, v0
  v_lshrrev_b32 v4, 5, v0
  v_and_b32 v1, 7, v0
  v_xor_b32 v1, v1, v4
  v_lshlrev_b32 v1, 4, v1
  v_lshl_add_u32 v1, v2, 7, v1
  v_add_u32 v208, s28, v1
  v_xor_b32 v209, 32, v208
  v_xor_b32 v210, 64, v208
  v_xor_b32 v211, 0x60, v208
  v_lshl_add_u32 v212, v0, 4, s28
  v_lshrrev_b32 v2, 3, v0
  v_and_b32 v1, 7, v0
  v_xor_b32 v1, v1, v2
  v_lshlrev_b32 v1, 4, v1
  v_lshl_add_u32 v213, v2, 11, v1
  s_add_u32 s31, s30, 0x4000
  s_add_u32 s32, s30, 0x8000
  s_add_u32 s33, s30, 0xc000
  s_barrier
L3_go:
  s_movk_i32 s29, 0
  buffer_load_dwordx4 v[32:35], v5, s[16:19], s29 offen offset:0 sc1
  buffer_load_dwordx4 v[36:39], v5, s[16:19], s29 offen offset:1024 sc1
  buffer_load_dwordx4 v[40:43], v5, s[16:19], s29 offen offset:2048 sc1
  buffer_load_dwordx4 v[44:47], v5, s[16:19], s29 offen offset:3072 sc1
  s_movk_i32 s29, 4096
  buffer_load_dwordx4 v[48:51], v5, s[16:19], s29 offen offset:0 sc1
  buffer_load_dwordx4 v[52:55], v5, s[16:19], s29 offen offset:1024 sc1
  buffer_load_dwordx4 v[56:59], v5, s[16:19], s29 offen offset:2048 sc1
  buffer_load_dwordx4 v[60:63], v5, s[16:19], s29 offen offset:3072 sc1
  s_movk_i32 s29, 8192
  buffer_load_dwordx4 v[64:67], v5, s[16:19], s29 offen offset:0 sc1
  buffer_load_dwordx4 v[68:71], v5, s[16:19], s29 offen offset:1024 sc1
  buffer_load_dwordx4 v[72:75], v5, s[16:19], s29 offen offset:2048 sc1
  buffer_load_dwordx4 v[76:79], v5, s[16:19], s29 offen offset:3072 sc1
  ds_read_b64_tr_b16 v[8:9], v6 offset:0
  ds_read_b64_tr_b16 v[10:11], v6 offset:1024
  ds_read_b64_tr_b16 v[12:13], v7 offset:0
  ds_read_b64_tr_b16 v[14:15], v7 offset:1024
  ds_read_b64_tr_b16 v[16:17], v6 offset:2048
  ds_read_b64_tr_b16 v[18:19], v6 offset:3072
  ds_read_b64_tr_b16 v[20:21], v7 offset:2048
  ds_read_b64_tr_b16 v[22:23], v7 offset:3072
  s_waitcnt vmcnt(11) lgkmcnt(4)
  v_mfma_f32_32x32x16_bf16 v[160:175], v[8:11], v[32:35], 0
  ds_read_b64_tr_b16 v[192:193], v6 offset:4096
  ds_read_b64_tr_b16 v[194:195], v6 offset:5120
  s_movk_i32 s29, 12288
  buffer_load_dwordx4 v[80:83], v5, s[16:19], s29 offen offset:0 sc1
  v_mfma_f32_32x32x16_bf16 v[176:191], v[12:15], v[32:35], 0
  ds_read_b64_tr_b16 v[196:197], v7 offset:4096
  ds_read_b64_tr_b16 v[198:199], v7 offset:5120
  s_waitcnt vmcnt(11) lgkmcnt(4)
  v_mfma_f32_32x32x16_bf16 v[160:175], v[16:19], v[36:39], v[160:175]
  ds_read_b64_tr_b16 v[200:201], v6 offset:6144
  ds_read_b64_tr_b16 v[202:203], v6 offset:7168
  buffer_load_dwordx4 v[84:87], v5, s[16:19], s29 offen offset:1024 sc1
  v_mfma_f32_32x32x16_bf16 v[176:191], v[20:23], v[36:39], v[176:191]
  ds_read_b64_tr_b16 v[204:205], v7 offset:6144
  ds_read_b64_tr_b16 v[206:207], v7 offset:7168
  s_waitcnt vmcnt(11) lgkmcnt(4)
  v_mfma_f32_32x32x16_bf16 v[160:175], v[192:195], v[40:43], v[160:175]
  ds_read_b64_tr_b16 v[8:9], v6 offset:8192
  ds_read_b64_tr_b16 v[10:11], v6 offset:9216
  buffer_load_dwordx4 v[88:91], v5, s[16:19], s29 offen offset:2048 sc1
  v_mfma_f32_32x32x16_bf16 v[176:191], v[196:199], v[40:43], v[176:191]
  ds_read_b64_tr_b16 v[12:13], v7 offset:8192
  ds_read_b64_tr_b16 v[14:15], v7 offset:9216
  s_waitcnt vmcnt(11) lgkmcnt(4)
  v_mfma_f32_32x32x16_bf16 v[160:175], v[200:203], v[44:47], v[160:175]
  ds_read_b64_tr_b16 v[16:17], v6 offset:10240
  ds_read_b64_tr_b16 v[18:19], v6 offset:11264
  buffer_load_dwordx4 v[92:95], v5, s[16:19], s29 offen offset:3072 sc1
  v_mfma_f32_32x32x16_bf16 v[176:191], v[204:207], v[44:47], v[176:191]
  ds_read_b64_tr_b16 v[20:21], v7 offset:10240
  ds_read_b64_tr_b16 v[22:23], v7 offset:11264
  s_waitcnt vmcnt(11) lgkmcnt(4)
  v_mfma_f32_32x32x16_bf16 v[160:175], v[8:11], v[48:51], v[160:175]
  ds_read_b64_tr_b16 v[192:193], v6 offset:12288
  ds_read_b64_tr_b16 v[194:195], v6 offset:13312
  s_movk_i32 s29, 16384
  buffer_load_dwordx4 v[96:99], v5, s[16:19], s29 offen offset:0 sc1
  v_mfma_f32_32x32x16_bf16 v[176:191], v[12:15], v[48:51], v[176:191]
  ds_read_b64_tr_b16 v[196:197], v7 offset:12288
  ds_read_b64_tr_b16 v[198:199], v7 offset:13312
  s_waitcnt vmcnt(11) lgkmcnt(4)
  v_mfma_f32_32x32x16_bf16 v[160:175], v[16:19], v[52:55], v[160:175]
  ds_read_b64_tr_b16 v[200:201], v6 offset:14336
  ds_read_b64_tr_b16 v[202:203], v6 offset:15360
  buffer_load_dwordx4 v[100:103], v5, s[16:19], s29 offen offset:1024 sc1
  v_mfma_f32_32x32x16_bf16 v[176:191], v[20:23], v[52:55], v[176:191]
  ds_read_b64_tr_b16 v[204:205], v7 offset:14336
  ds_read_b64_tr_b16 v[206:207], v7 offset:15360
  s_waitcnt vmcnt(11) lgkmcnt(4)
  v_mfma_f32_32x32x16_bf16 v[160:175], v[192:195], v[56:59], v[160:175]
  ds_read_b64_tr_b16 v[8:9], v6 offset:16384
  ds_read_b64_tr_b16 v[10:11], v6 offset:17408
  buffer_load_dwordx4 v[104:107], v5, s[16:19], s29 offen offset:2048 sc1
  v_mfma_f32_32x32x16_bf16 v[176:191], v[196:199], v[56:59], v[176:191]
  ds_read_b64_tr_b16 v[12:13], v7 offset:16384
  ds_read_b64_tr_b16 v[14:15], v7 offset:17408
  s_waitcnt vmcnt(11) lgkmcnt(4)
  v_mfma_f32_32x32x16_bf16 v[160:175], v[200:203], v[60:63], v[160:175]
  ds_read_b64_tr_b16 v[16:17], v6 offset:18432
  ds_read_b64_tr_b16 v[18:19], v6 offset:19456
  buffer_load_dwordx4 v[108:111], v5, s[16:19], s29 offen offset:3072 sc1
  v_mfma_f32_32x32x16_bf16 v[176:191], v[204:207], v[60:63], v[176:191]
  ds_read_b64_tr_b16 v[20:21], v7 offset:18432
  ds_read_b64_tr_b16 v[22:23], v7 offset:19456
  s_waitcnt vmcnt(11) lgkmcnt(4)
  v_mfma_f32_32x32x16_bf16 v[160:175], v[8:11], v[64:67], v[160:175]
  ds_read_b64_tr_b16 v[192:193], v6 offset:20480
  ds_read_b64_tr_b16 v[194:195], v6 offset:21504
  s_movk_i32 s29, 20480
  buffer_load_dwordx4 v[112:115], v5, s[16:19], s29 offen offset:0 sc1
  v_mfma_f32_32x32x16_bf16 v[176:191], v[12:15], v[64:67], v[176:191]
  ds_read_b64_tr_b16 v[196:197], v7 offset:20480
  ds_read_b64_tr_b16 v[198:199], v7 offset:21504
  s_waitcnt vmcnt(11) lgkmcnt(4)
  v_mfma_f32_32x32x16_bf16 v[160:175], v[16:19], v[68:71], v[160:175]
  ds_read_b64_tr_b16 v[200:201], v6 offset:22528
  ds_read_b64_tr_b16 v[202:203], v6 offset:23552
  buffer_load_dwordx4 v[116:119], v5, s[16:19], s29 offen offset:1024 sc1
  v_mfma_f32_32x32x16_bf16 v[176:191], v[20:23], v[68:71], v[176:191]
  ds_read_b64_tr_b16 v[204:205], v7 offset:22528
  ds_read_b64_tr_b16 v[206:207], v7 offset:23552
  s_waitcnt vmcnt(11) lgkmcnt(4)
  v_mfma_f32_32x32x16_bf16 v[160:175], v[192:195], v[72:75], v[160:175]
  ds_read_b64_tr_b16 v[8:9], v6 offset:24576
  ds_read_b64_tr_b16 v[10:11], v6 offset:25600
  buffer_load_dwordx4 v[120:123], v5, s[16:19], s29 offen offset:2048 sc1
  v_mfma_f32_32x32x16_bf16 v[176:191], v[196:199], v[72:75], v[176:191]
  ds_read_b64_tr_b16 v[12:13], v7 offset:24576
  ds_read_b64_tr_b16 v[14:15], v7 offset:25600
  s_waitcnt vmcnt(11) lgkmcnt(4)
  v_mfma_f32_32x32x16_bf16 v[160:175], v[200:203], v[76:79], v[160:175]
  ds_read_b64_tr_b16 v[16:17], v6 offset:26624
  ds_read_b64_tr_b16 v[18:19], v6 offset:27648
  buffer_load_dwordx4 v[124:127], v5, s[16:19], s29 offen offset:3072 sc1
  v_mfma_f32_32x32x16_bf16 v[176:191], v[204:207], v[76:79], v[176:191]
  ds_read_b64_tr_b16 v[20:21], v7 offset:26624
  ds_read_b64_tr_b16 v[22:23], v7 offset:27648
  s_waitcnt vmcnt(11) lgkmcnt(4)
  v_mfma_f32_32x32x16_bf16 v[160:175], v[8:11], v[80:83], v[160:175]
  ds_read_b64_tr_b16 v[192:193], v6 offset:28672
  ds_read_b64_tr_b16 v[194:195], v6 offset:29696
  s_movk_i32 s29, 24576
  buffer_load_dwordx4 v[128:131], v5, s[16:19], s29 offen offset:0 sc1
  v_mfma_f32_32x32x16_bf16 v[176:191], v[12:15], v[80:83], v[176:191]
  ds_read_b64_tr_b16 v[196:197], v7 offset:28672
  ds_read_b64_tr_b16 v[198:199], v7 offset:29696
  s_waitcnt vmcnt(11) lgkmcnt(4)
  v_mfma_f32_32x32x16_bf16 v[160:175], v[16:19], v[84:87], v[160:175]
  ds_read_b64_tr_b16 v[200:201], v6 offset:30720
  ds_read_b64_tr_b16 v[202:203], v6 offset:31744
  buffer_load_dwordx4 v[132:135], v5, s[16:19], s29 offen offset:1024 sc1
  v_mfma_f32_32x32x16_bf16 v[176:191], v[20:23], v[84:87], v[176:191]
  ds_read_b64_tr_b16 v[204:205], v7 offset:30720
  ds_read_b64_tr_b16 v[206:207], v7 offset:31744
  s_waitcnt vmcnt(11) lgkmcnt(4)
  v_mfma_f32_32x32x16_bf16 v[160:175], v[192:195], v[88:91], v[160:175]
  ds_read_b64_tr_b16 v[8:9], v6 offset:32768
  ds_read_b64_tr_b16 v[10:11], v6 offset:33792
  buffer_load_dwordx4 v[136:139], v5, s[16:19], s29 offen offset:2048 sc1
  v_mfma_f32_32x32x16_bf16 v[176:191], v[196:199], v[88:91], v[176:191]
  ds_read_b64_tr_b16 v[12:13], v7 offset:32768
  ds_read_b64_tr_b16 v[14:15], v7 offset:33792
  s_waitcnt vmcnt(11) lgkmcnt(4)
  v_mfma_f32_32x32x16_bf16 v[160:175], v[200:203], v[92:95], v[160:175]
  ds_read_b64_tr_b16 v[16:17], v6 offset:34816
  ds_read_b64_tr_b16 v[18:19], v6 offset:35840
  buffer_load_dwordx4 v[140:143], v5, s[16:19], s29 offen offset:3072 sc1
  v_mfma_f32_32x32x16_bf16 v[176:191], v[204:207], v[92:95], v[176:191]
  ds_read_b64_tr_b16 v[20:21], v7 offset:34816
  ds_read_b64_tr_b16 v[22:23], v7 offset:35840
  s_waitcnt vmcnt(11) lgkmcnt(4)
  v_mfma_f32_32x32x16_bf16 v[160:175], v[8:11], v[96:99], v[160:175]
  ds_read_b64_tr_b16 v[192:193], v6 offset:36864
  ds_read_b64_tr_b16 v[194:195], v6 offset:37888
  s_movk_i32 s29, 28672
  buffer_load_dwordx4 v[144:147], v5, s[16:19], s29 offen offset:0 sc1
  v_mfma_f32_32x32x16_bf16 v[176:191], v[12:15], v[96:99], v[176:191]
  ds_read_b64_tr_b16 v[196:197], v7 offset:36864
  ds_read_b64_tr_b16 v[198:199], v7 offset:37888
  s_waitcnt vmcnt(11) lgkmcnt(4)
  v_mfma_f32_32x32x16_bf16 v[160:175], v[16:19], v[100:103], v[160:175]
  ds_read_b64_tr_b16 v[200:201], v6 offset:38912
  ds_read_b64_tr_b16 v[202:203], v6 offset:39936
  buffer_load_dwordx4 v[148:151], v5, s[16:19], s29 offen offset:1024 sc1
  v_mfma_f32_32x32x16_bf16 v[176:191], v[20:23], v[100:103], v[176:191]
  ds_read_b64_tr_b16 v[204:205], v7 offset:38912
  ds_read_b64_tr_b16 v[206:207], v7 offset:39936
  s_waitcnt vmcnt(11) lgkmcnt(4)
  v_mfma_f32_32x32x16_bf16 v[160:175], v[192:195], v[104:107], v[160:175]
  ds_read_b64_tr_b16 v[8:9], v6 offset:40960
  ds_read_b64_tr_b16 v[10:11], v6 offset:41984
  buffer_load_dwordx4 v[152:155], v5, s[16:19], s29 offen offset:2048 sc1
  v_mfma_f32_32x32x16_bf16 v[176:191], v[196:199], v[104:107], v[176:191]
  ds_read_b64_tr_b16 v[12:13], v7 offset:40960
  ds_read_b64_tr_b16 v[14:15], v7 offset:41984
  s_waitcnt vmcnt(11) lgkmcnt(4)
  v_mfma_f32_32x32x16_bf16 v[160:175], v[200:203], v[108:111], v[160:175]
  ds_read_b64_tr_b16 v[16:17], v6 offset:43008
  ds_read_b64_tr_b16 v[18:19], v6 offset:44032
  buffer_load_dwordx4 v[156:159], v5, s[16:19], s29 offen offset:3072 sc1
  v_mfma_f32_32x32x16_bf16 v[176:191], v[204:207], v[108:111], v[176:191]
  ds_read_b64_tr_b16 v[20:21], v7 offset:43008
  ds_read_b64_tr_b16 v[22:23], v7 offset:44032
  s_waitcnt vmcnt(11) lgkmcnt(4)
  v_mfma_f32_32x32x16_bf16 v[160:175], v[8:11], v[112:115], v[160:175]
  ds_read_b64_tr_b16 v[192:193], v6 offset:45056
  ds_read_b64_tr_b16 v[194:195], v6 offset:46080
  v_mfma_f32_32x32x16_bf16 v[176:191], v[12:15], v[112:115], v[176:191]
  ds_read_b64_tr_b16 v[196:197], v7 offset:45056
  ds_read_b64_tr_b16 v[198:199], v7 offset:46080
  s_waitcnt vmcnt(10) lgkmcnt(4)
  v_mfma_f32_32x32x16_bf16 v[160:175], v[16:19], v[116:119], v[160:175]
  ds_read_b64_tr_b16 v[200:201], v6 offset:47104
  ds_read_b64_tr_b16 v[202:203], v6 offset:48128
  v_mfma_f32_32x32x16_bf16 v[176:191], v[20:23], v[116:119], v[176:191]
  ds_read_b64_tr_b16 v[204:205], v7 offset:47104
  ds_read_b64_tr_b16 v[206:207], v7 offset:48128
  s_waitcnt vmcnt(9) lgkmcnt(4)
  v_mfma_f32_32x32x16_bf16 v[160:175], v[192:195], v[120:123], v[160:175]
  ds_read_b64_tr_b16 v[8:9], v6 offset:49152
  ds_read_b64_tr_b16 v[10:11], v6 offset:50176
  v_mfma_f32_32x32x16_bf16 v[176:191], v[196:199], v[120:123], v[176:191]
  ds_read_b64_tr_b16 v[12:13], v7 offset:49152
  ds_read_b64_tr_b16 v[14:15], v7 offset:50176
  s_waitcnt vmcnt(8) lgkmcnt(4)
  v_mfma_f32_32x32x16_bf16 v[160:175], v[200:203], v[124:127], v[160:175]
  ds_read_b64_tr_b16 v[16:17], v6 offset:51200
  ds_read_b64_tr_b16 v[18:19], v6 offset:52224
  v_mfma_f32_32x32x16_bf16 v[176:191], v[204:207], v[124:127], v[176:191]
  ds_read_b64_tr_b16 v[20:21], v7 offset:51200
  ds_read_b64_tr_b16 v[22:23], v7 offset:52224
  s_waitcnt vmcnt(7) lgkmcnt(4)
  v_mfma_f32_32x32x16_bf16 v[160:175], v[8:11], v[128:131], v[160:175]
  ds_read_b64_tr_b16 v[192:193], v6 offset:53248
  ds_read_b64_tr_b16 v[194:195], v6 offset:54272
  v_mfma_f32_32x32x16_bf16 v[176:191], v[12:15], v[128:131], v[176:191]
  ds_read_b64_tr_b16 v[196:197], v7 offset:53248
  ds_read_b64_tr_b16 v[198:199], v7 offset:54272
  s_waitcnt vmcnt(6) lgkmcnt(4)
  v_mfma_f32_32x32x16_bf16 v[160:175], v[16:19], v[132:135], v[160:175]
  ds_read_b64_tr_b16 v[200:201], v6 offset:55296
  ds_read_b64_tr_b16 v[202:203], v6 offset:56320
  v_mfma_f32_32x32x16_bf16 v[176:191], v[20:23], v[132:135], v[176:191]
  ds_read_b64_tr_b16 v[204:205], v7 offset:55296
  ds_read_b64_tr_b16 v[206:207], v7 offset:56320
  s_waitcnt vmcnt(5) lgkmcnt(4)
  v_mfma_f32_32x32x16_bf16 v[160:175], v[192:195], v[136:139], v[160:175]
  ds_read_b64_tr_b16 v[8:9], v6 offset:57344
  ds_read_b64_tr_b16 v[10:11], v6 offset:58368
  v_mfma_f32_32x32x16_bf16 v[176:191], v[196:199], v[136:139], v[176:191]
  ds_read_b64_tr_b16 v[12:13], v7 offset:57344
  ds_read_b64_tr_b16 v[14:15], v7 offset:58368
  s_waitcnt vmcnt(4) lgkmcnt(4)
  v_mfma_f32_32x32x16_bf16 v[160:175], v[200:203], v[140:143], v[160:175]
  ds_read_b64_tr_b16 v[16:17], v6 offset:59392
  ds_read_b64_tr_b16 v[18:19], v6 offset:60416
  v_mfma_f32_32x32x16_bf16 v[176:191], v[204:207], v[140:143], v[176:191]
  ds_read_b64_tr_b16 v[20:21], v7 offset:59392
  ds_read_b64_tr_b16 v[22:23], v7 offset:60416
  s_waitcnt vmcnt(3) lgkmcnt(4)
  v_mfma_f32_32x32x16_bf16 v[160:175], v[8:11], v[144:147], v[160:175]
  ds_read_b64_tr_b16 v[192:193], v6 offset:61440
  ds_read_b64_tr_b16 v[194:195], v6 offset:62464
  v_mfma_f32_32x32x16_bf16 v[176:191], v[12:15], v[144:147], v[176:191]
  ds_read_b64_tr_b16 v[196:197], v7 offset:61440
  ds_read_b64_tr_b16 v[198:199], v7 offset:62464
  s_waitcnt vmcnt(2) lgkmcnt(4)
  v_mfma_f32_32x32x16_bf16 v[160:175], v[16:19], v[148:151], v[160:175]
  ds_read_b64_tr_b16 v[200:201], v6 offset:63488
  ds_read_b64_tr_b16 v[202:203], v6 offset:64512
  v_mfma_f32_32x32x16_bf16 v[176:191], v[20:23], v[148:151], v[176:191]
  ds_read_b64_tr_b16 v[204:205], v7 offset:63488
  ds_read_b64_tr_b16 v[206:207], v7 offset:64512
  s_waitcnt vmcnt(1) lgkmcnt(4)
  v_mfma_f32_32x32x16_bf16 v[160:175], v[192:195], v[152:155], v[160:175]
  v_mfma_f32_32x32x16_bf16 v[176:191], v[196:199], v[152:155], v[176:191]
  s_waitcnt vmcnt(0) lgkmcnt(0)
  v_mfma_f32_32x32x16_bf16 v[160:175], v[200:203], v[156:159], v[160:175]
  v_mfma_f32_32x32x16_bf16 v[176:191], v[204:207], v[156:159], v[176:191]
  s_nop 7
  s_nop 3
  v_cvt_pk_bf16_f32 v160, v160, v161
  v_cvt_pk_bf16_f32 v161, v162, v163
  v_cvt_pk_bf16_f32 v162, v164, v165
  v_cvt_pk_bf16_f32 v163, v166, v167
  v_cvt_pk_bf16_f32 v164, v168, v169
  v_cvt_pk_bf16_f32 v165, v170, v171
  v_cvt_pk_bf16_f32 v166, v172, v173
  v_cvt_pk_bf16_f32 v167, v174, v175
  ds_write_b128 v208, v[160:163]
  ds_write_b128 v209, v[164:167]
  v_cvt_pk_bf16_f32 v176, v176, v177
  v_cvt_pk_bf16_f32 v177, v178, v179
  v_cvt_pk_bf16_f32 v178, v180, v181
  v_cvt_pk_bf16_f32 v179, v182, v183
  v_cvt_pk_bf16_f32 v180, v184, v185
  v_cvt_pk_bf16_f32 v181, v186, v187
  v_cvt_pk_bf16_f32 v182, v188, v189
  v_cvt_pk_bf16_f32 v183, v190, v191
  ds_write_b128 v210, v[176:179]
  ds_write_b128 v211, v[180:183]
  s_waitcnt lgkmcnt(0)
  ds_read_b128 v[32:35], v212 offset:0
  ds_read_b128 v[36:39], v212 offset:1024
  ds_read_b128 v[40:43], v212 offset:2048
  ds_read_b128 v[44:47], v212 offset:3072
  s_waitcnt lgkmcnt(3)
  buffer_store_dwordx4 v[32:35], v213, s[4:7], s30 offen sc1
  s_waitcnt lgkmcnt(2)
  buffer_store_dwordx4 v[36:39], v213, s[4:7], s31 offen sc1
  s_waitcnt lgkmcnt(1)
  buffer_store_dwordx4 v[40:43], v213, s[4:7], s32 offen sc1
  s_waitcnt lgkmcnt(0)
  buffer_store_dwordx4 v[44:47], v213, s[4:7], s33 offen sc1
  s_endpgm
L2_slow:
  s_waitcnt vmcnt(0)
  v_subrev_u32 v2, 65536, v2
  v_subrev_u32 v3, 67584, v3
  v_subrev_u32 v4, 67584, v4
L2_slowq:
  v_mov_b32 v1, 0xff800000
  v_mov_b32 v6, v2
  s_mov_b32 s35, 0
L2_max:
  ds_read_b128 v[24:27], v6
  v_add_u32 v6, 1024, v6
  s_waitcnt lgkmcnt(0)
  v_mfma_f32_32x32x16_bf16 v[48:63], v[24:27], v[8:11], 0
  s_nop 7
  s_nop 7
  v_max3_f32 v1, v1, v48, v49
  v_max3_f32 v1, v1, v50, v51
  v_max3_f32 v1, v1, v52, v53
  v_max3_f32 v1, v1, v54, v55
  v_max3_f32 v1, v1, v56, v57
  v_max3_f32 v1, v1, v58, v59
  v_max3_f32 v1, v1, v60, v61
  v_max3_f32 v1, v1, v62, v63
  s_add_u32 s35, s35, 1
  s_cmp_lt_u32 s35, 64
  s_cbranch_scc1 L2_max
  v_mov_b32 v6, v1
  s_nop 1
  v_permlane32_swap_b32 v1, v6
  s_nop 1
  v_max_f32 v1, v1, v6
  v_sub_f32 v144, 0, v1
  v_sub_f32 v145, 0, v1
  v_sub_f32 v146, 0, v1
  v_sub_f32 v147, 0, v1
  v_sub_f32 v148, 0, v1
  v_sub_f32 v149, 0, v1
  v_sub_f32 v150, 0, v1
  v_sub_f32 v151, 0, v1
  v_sub_f32 v152, 0, v1
  v_sub_f32 v153, 0, v1
  v_sub_f32 v154, 0, v1
  v_sub_f32 v155, 0, v1
  v_sub_f32 v156, 0, v1
  v_sub_f32 v157, 0, v1
  v_sub_f32 v158, 0, v1
  v_sub_f32 v159, 0, v1
  v_mov_b32 v80, 0
  v_mov_b32 v81, 0
  v_mov_b32 v82, 0
  v_mov_b32 v83, 0
  v_mov_b32 v84, 0
  v_mov_b32 v85, 0
  v_mov_b32 v86, 0
  v_mov_b32 v87, 0
  v_mov_b32 v88, 0
  v_mov_b32 v89, 0
  v_mov_b32 v90, 0
  v_mov_b32 v91, 0
  v_mov_b32 v92, 0
  v_mov_b32 v93, 0
  v_mov_b32 v94, 0
  v_mov_b32 v95, 0
  v_mov_b32 v6, v2
  v_mov_b32 v160, v3
  v_mov_b32 v161, v4
  s_mov_b32 s35, 0
L2_acc:
  ds_read_b128 v[24:27], v6
  ds_read_b128 v[32:35], v160
  ds_read_b128 v[36:39], v161
  v_add_u32 v6, 1024, v6
  v_add_u32 v160, 1056, v160
  v_add_u32 v161, 1056, v161
  s_waitcnt lgkmcnt(0)
  v_mfma_f32_32x32x16_bf16 v[48:63], v[24:27], v[8:11], v[144:159]
  s_nop 7
  s_nop 7
  v_exp_f32 v48, v48
  v_exp_f32 v49, v49
  v_exp_f32 v50, v50
  v_exp_f32 v51, v51
  v_exp_f32 v52, v52
  v_exp_f32 v53, v53
  v_exp_f32 v54, v54
  v_exp_f32 v55, v55
  v_exp_f32 v56, v56
  v_exp_f32 v57, v57
  v_exp_f32 v58, v58
  v_exp_f32 v59, v59
  v_exp_f32 v60, v60
  v_exp_f32 v61, v61
  v_exp_f32 v62, v62
  v_exp_f32 v63, v63
  s_nop 2
  v_smfmac_f32_32x32x32_bf16 v[80:95], v[32:35], v[48:55], v7
  v_smfmac_f32_32x32x32_bf16 v[80:95], v[36:39], v[56:63], v7
  s_add_u32 s35, s35, 1
  s_cmp_lt_u32 s35, 64
  s_cbranch_scc1 L2_acc
  s_nop 7
  s_nop 7
  v_swap_b32 v8, v12
  v_swap_b32 v12, v16
  v_swap_b32 v16, v20
  v_swap_b32 v9, v13
  v_swap_b32 v13, v17
  v_swap_b32 v17, v21
  v_swap_b32 v10, v14
  v_swap_b32 v14, v18
  v_swap_b32 v18, v22
  v_swap_b32 v11, v15
  v_swap_b32 v15, v19
  v_swap_b32 v19, v23
  v_swap_b32 v80, v96
  v_swap_b32 v96, v112
  v_swap_b32 v112, v128
  v_swap_b32 v81, v97
  v_swap_b32 v97, v113
  v_swap_b32 v113, v129
  v_swap_b32 v82, v98
  v_swap_b32 v98, v114
  v_swap_b32 v114, v130
  v_swap_b32 v83, v99
  v_swap_b32 v99, v115
  v_swap_b32 v115, v131
  v_swap_b32 v84, v100
  v_swap_b32 v100, v116
  v_swap_b32 v116, v132
  v_swap_b32 v85, v101
  v_swap_b32 v101, v117
  v_swap_b32 v117, v133
  v_swap_b32 v86, v102
  v_swap_b32 v102, v118
  v_swap_b32 v118, v134
  v_swap_b32 v87, v103
  v_swap_b32 v103, v119
  v_swap_b32 v119, v135
  v_swap_b32 v88, v104
  v_swap_b32 v104, v120
  v_swap_b32 v120, v136
  s_add_u32 s54, s54, 1
  s_cmp_lt_u32 s54, 4
  s_cbranch_scc1 L2_slowq
  s_branch L2_fin
L1_report:
  s_mov_b32 s44, 1
  v_mov_b32 v216, v224
  v_mov_b32 v217, v225
  s_mov_b64 exec, 1
  buffer_store_dwordx4 v[216:219], v220, s[12:15], s45 offen sc1
  s_mov_b64 exec, -1
  s_branch L1_reported
L1_cspin:
  buffer_load_dwordx2 v[224:225], v220, s[8:11], 0 offen sc1
  buffer_load_dwordx4 v[228:231], v221, s[12:15], s41 offen sc1
  s_sleep 1
  s_add_u32 s58, s58, 1
  s_cmp_lt_u32 s58, 131072
  s_cbranch_scc1 L1_census
  s_waitcnt vmcnt(0)
  s_branch L1_cdone
L1_slowrel:
  buffer_wbl2 sc1
  s_waitcnt vmcnt(0)
  buffer_store_dwordx2 v[224:225], v220, s[12:15], s42 offen sc1
  s_branch L1_reldone
L_end:
.section .rodata,"a"
.p2align 6
.amdhsa_kernel concat_heads__mha_block__softmax_full_mha__prompt_kernel
  .amdhsa_next_free_vgpr 256
  .amdhsa_next_free_sgpr 102
  .amdhsa_accum_offset 256
  .amdhsa_group_segment_fixed_size 0
  .amdhsa_kernarg_size 72
  .amdhsa_user_sgpr_count 2
  .amdhsa_user_sgpr_kernarg_segment_ptr 1
  .amdhsa_system_sgpr_workgroup_id_x 1
.end_amdhsa_kernel
```
